```python
import torch

def _softmax(x, axis=-1):
    return torch.softmax(x, dim=axis)
def _gelu(x):
    return torch.nn.functional.gelu(x, approximate="tanh")
def _silu(x):
    return torch.nn.functional.silu(x)
def _sigmoid(x):
    return torch.sigmoid(x)
def _layernorm(x, axis=-1, eps=1e-5):
    m = x.mean(dim=axis, keepdim=True)
    v = x.var(dim=axis, keepdim=True, unbiased=False)
    return (x - m) / torch.sqrt(v + eps)
def _scatter_add(tgt, idx, src, axis=0):
    return tgt.clone().index_add_(axis, idx, src)
def _segment_sum(src, seg, n):
    out = torch.zeros((n,) + src.shape[1:], dtype=src.dtype)
    return out.index_add_(0, seg, src)
def _pad(x, pw):
    flat = tuple(v for pair in reversed(pw) for v in pair)
    return torch.nn.functional.pad(x, flat)

kernel_name = 'gated_mix__grouped_kv_mqa__glu_gated_reglu__prompt'

def setup_inputs():

    _w = (lambda a: (lambda t: t.to(torch.bfloat16) if t.is_floating_point() else t)(torch.as_tensor(a)))
    def _A_setup():
        B, S, D, H = 1, 2048, 640, 32
        Dh = D // H
        return {
            "x": _w((lambda *s: torch.randn(*s, dtype=torch.bfloat16) * 0.05)(B, S, D)),
            "wq": _w((lambda *s: torch.randn(*s, dtype=torch.bfloat16) * 0.8)(D, H * Dh)),
            "wk": _w((lambda *s: torch.randn(*s, dtype=torch.bfloat16) * 0.8)(D, Dh)),
            "wv": _w((lambda *s: torch.randn(*s, dtype=torch.bfloat16) * 0.05)(D, Dh)),
            "wo": _w((lambda *s: torch.randn(*s, dtype=torch.bfloat16) * 0.05)(H * Dh, D)),
        }
    _A_in = _A_setup()

    def _B_setup():
        B, S, D, F = 1, 2048, 640, 1536
        return {
            "x": _w((lambda *s: torch.randn(*s, dtype=torch.bfloat16) * 0.05)(B, S, D)),
            "W_gate": _w((lambda *s: torch.randn(*s, dtype=torch.bfloat16) * 0.8)(D, F) * (2.0 / D) ** 0.5),
            "W_up": _w((lambda *s: torch.randn(*s, dtype=torch.bfloat16) * 0.8)(D, F) * (2.0 / D) ** 0.5),
            "W_down": _w((lambda *s: torch.randn(*s, dtype=torch.bfloat16) * 0.8)(F, D) * (1.0 / F) ** 0.5),
        }
    _B_in = _B_setup()

    return {
        "A_x": _A_in["x"],
        "A_wq": _A_in["wq"],
        "A_wk": _A_in["wk"],
        "A_wv": _A_in["wv"],
        "A_wo": _A_in["wo"],
        "B_x": _B_in["x"],
        "B_W_gate": _B_in["W_gate"],
        "B_W_up": _B_in["W_up"],
        "B_W_down": _B_in["W_down"],
        "gate_w": _w((lambda *s: torch.randn(*s, dtype=torch.bfloat16) * 0.05)(640) * 16.0),
    }

def reference(A_x, A_wq, A_wk, A_wv, A_wo, B_x, B_W_gate, B_W_up, B_W_down, gate_w):
    def _A_ref(x, wq, wk, wv, wo):
        B, S, D = x.shape
        H = 32
        Dh = D // H
        q = (lambda x, *d: x.permute(*d))((x @ wq).reshape(B, S, H, Dh), 0, 2, 1, 3)
        k = x @ wk
        v = x @ wv
        scores = torch.einsum("bhqd,bkd->bhqk", q, k) * (Dh ** -0.5)
        p = _softmax(scores, axis=-1)
        o = torch.einsum("bhqk,bkd->bhqd", p, v)
        return (lambda x, *d: x.permute(*d))(o, 0, 2, 1, 3).reshape(B, S, H * Dh) @ wo

    def _B_ref(x, W_gate, W_up, W_down):
        gate = torch.einsum("bsd,df->bsf", x, W_gate)
        up = torch.einsum("bsd,df->bsf", x, W_up)
        gate = gate * (lambda x, dt: x.to(dt))(gate > 0, gate.dtype)
        h = gate * up
        return torch.einsum("bsf,fd->bsd", h, W_down)

    x = A_x
    g = _sigmoid((x * gate_w).sum(-1, keepdims=True))
    a = _A_ref(x, A_wq, A_wk, A_wv, A_wo)
    b = _B_ref(x, B_W_gate, B_W_up, B_W_down)
    return g * a + (1 - g) * b
```

```asm
; @launch kernel=proj_kernel grid=(248,1,1) block=(512,1,1) lds=147456
; @launch kernel=att_kernel grid=(416,1,1) block=(512,1,1) lds=81920
; @launch kernel=out_kernel grid=(240,1,1) block=(192,1,1) lds=147456
.amdgcn_target "amdgcn-amd-amdhsa--gfx950"
.text
.globl proj_kernel
.p2align 8
.type proj_kernel,@function
proj_kernel:
    s_cmp_ge_u32 s2, 248
    s_cbranch_scc1 Lp_end
    s_load_dwordx2 s[98:99], s[0:1], 96
    s_load_dwordx16 s[64:79], s[0:1], 0
    s_load_dwordx8 s[80:87], s[0:1], 64
    v_lshrrev_b32 v1, 6, v0
    v_and_b32 v0, 63, v0
    s_nop 0
    v_readfirstlane_b32 s20, v1
    s_cmp_ge_u32 s2, 232
    s_cbranch_scc1 Lp_kv
    s_cmp_ge_u32 s2, 192
    s_cbranch_scc1 Lp_q
    s_and_b32 s26, s2, 1
    s_lshl_b32 s26, s26, 2
    s_bfe_u32 s27, s2, 0x20003
    s_add_u32 s26, s26, s27
    s_lshl_b32 s21, s26, 8
    s_mul_i32 s35, s27, 3
    s_bfe_u32 s26, s2, 0x20001
    s_mul_i32 s26, s26, 6
    s_lshr_b32 s27, s2, 5
    s_add_u32 s26, s26, s27
    s_lshl_b32 s22, s26, 7
    s_mov_b32 s23, s22
    s_mov_b32 s24, 0
    s_mul_i32 s27, s27, 7
    s_add_u32 s35, s35, s27
    s_mul_i32 s26, s35, 6554
    s_lshr_b32 s26, s26, 16
    s_mul_i32 s26, s26, 10
    s_sub_u32 s35, s35, s26
    s_cmp_ge_u32 s20, 4
    s_cselect_b32 s25, s23, s22
    s_lshl_b32 s26, s20, 5
    s_add_u32 s26, s26, s21
    v_lshrrev_b32 v1, 3, v0
    v_add_u32 v1, s26, v1
    s_mov_b32 s27, 1280
    v_mul_lo_u32 v2, v1, s27
    s_lshl_b32 s26, s24, 1
    v_add_u32 v2, s26, v2
    v_lshrrev_b32 v1, 4, v0
    v_xor_b32 v1, v1, v0
    v_and_b32 v1, 7, v1
    v_xor_b32 v9, 4, v1
    v_add_u32 v3, 10240, v2
    v_lshl_add_u32 v2, v1, 4, v2
    v_lshl_add_u32 v3, v9, 4, v3
    v_add_u32 v4, 20480, v2
    v_add_u32 v5, 20480, v3
    s_and_b32 s26, s20, 3
    s_mul_i32 s26, s26, 16
    s_add_u32 s26, s26, s24
    v_lshrrev_b32 v1, 3, v0
    v_add_u32 v1, s26, v1
    s_mov_b32 s27, 3072
    v_mul_lo_u32 v10, v1, s27
    v_lshrrev_b32 v1, 2, v0
    v_and_b32 v1, 4, v1
    v_xor_b32 v1, v1, v0
    v_and_b32 v1, 7, v1
    v_lshl_add_u32 v10, v1, 4, v10
    v_add_u32 v10, s25, v10
    v_add_u32 v11, 24576, v10
    s_lshl_b32 s28, s20, 12
    s_mul_i32 s38, s20, 2048
    s_lshl_b32 s29, s35, 7
    s_mul_i32 s30, s35, 196608
    s_waitcnt lgkmcnt(0)
    s_mov_b32 s4, s64
    s_mov_b32 s5, s65
    s_mov_b32 s6, 2621440
    s_mov_b32 s7, 0x00020000
    s_mov_b32 s8, s76
    s_mov_b32 s9, s77
    s_mov_b32 s10, 1966080
    s_mov_b32 s11, 0x00020000
    s_mov_b32 s12, s78
    s_mov_b32 s13, s79
    s_mov_b32 s14, 1966080
    s_mov_b32 s15, 0x00020000
    s_cmp_ge_u32 s20, 4
    s_cselect_b32 s8, s12, s8
    s_cselect_b32 s9, s13, s9
    s_cselect_b32 s10, s14, s10
    s_add_u32 m0, s28, 0
    s_nop 0
    buffer_load_dwordx4 v2, s[4:7], s29 offen lds
    s_add_u32 m0, s28, 1024
    s_nop 0
    buffer_load_dwordx4 v3, s[4:7], s29 offen lds
    s_add_u32 m0, s28, 2048
    s_nop 0
    buffer_load_dwordx4 v4, s[4:7], s29 offen lds
    s_add_u32 m0, s28, 3072
    s_nop 0
    buffer_load_dwordx4 v5, s[4:7], s29 offen lds
    s_add_u32 s29, s29, 128
    s_cmp_eq_u32 s29, 1280
    s_cselect_b32 s29, 0, s29
    s_add_u32 m0, s38, 98304
    s_nop 0
    buffer_load_dwordx4 v10, s[8:11], s30 offen lds
    s_add_u32 m0, s38, 99328
    s_nop 0
    buffer_load_dwordx4 v11, s[8:11], s30 offen lds
    s_add_u32 s30, s30, 196608
    s_cmp_eq_u32 s30, 1966080
    s_cselect_b32 s30, 0, s30
    s_add_u32 m0, s28, 32768
    s_nop 0
    buffer_load_dwordx4 v2, s[4:7], s29 offen lds
    s_add_u32 m0, s28, 33792
    s_nop 0
    buffer_load_dwordx4 v3, s[4:7], s29 offen lds
    s_add_u32 m0, s28, 34816
    s_nop 0
    buffer_load_dwordx4 v4, s[4:7], s29 offen lds
    s_add_u32 m0, s28, 35840
    s_nop 0
    buffer_load_dwordx4 v5, s[4:7], s29 offen lds
    s_add_u32 s29, s29, 128
    s_cmp_eq_u32 s29, 1280
    s_cselect_b32 s29, 0, s29
    s_add_u32 m0, s38, 114688
    s_nop 0
    buffer_load_dwordx4 v10, s[8:11], s30 offen lds
    s_add_u32 m0, s38, 115712
    s_nop 0
    buffer_load_dwordx4 v11, s[8:11], s30 offen lds
    s_add_u32 s30, s30, 196608
    s_cmp_eq_u32 s30, 1966080
    s_cselect_b32 s30, 0, s30
    s_and_b32 s26, s20, 3
    s_lshl_b32 s26, s26, 6
    v_and_b32 v1, 31, v0
    v_add_u32 v1, s26, v1
    v_lshlrev_b32 v6, 7, v1
    v_lshrrev_b32 v1, 5, v0
    v_bfe_u32 v9, v0, 1, 3
    v_xor_b32 v1, v1, v9
    v_lshl_add_u32 v6, v1, 4, v6
    v_xor_b32 v7, 32, v6
    v_xor_b32 v14, 64, v6
    v_xor_b32 v15, 96, v6
    v_add_u32 v48, 65536, v6
    v_add_u32 v49, 65536, v7
    v_add_u32 v50, 65536, v14
    v_add_u32 v51, 65536, v15
    v_lshrrev_b32 v1, 5, v0
    v_lshlrev_b32 v1, 3, v1
    v_bfe_u32 v9, v0, 2, 2
    v_add_u32 v1, v1, v9
    v_lshlrev_b32 v8, 7, v1
    v_and_b32 v1, 1, v0
    v_lshlrev_b32 v1, 1, v1
    v_bfe_u32 v9, v0, 1, 1
    v_or_b32 v1, v1, v9
    v_lshlrev_b32 v1, 3, v1
    v_bfe_u32 v9, v0, 4, 1
    v_lshl_add_u32 v1, v9, 5, v1
    s_lshr_b32 s26, s20, 2
    s_lshl_b32 s26, s26, 6
    v_add_u32 v1, s26, v1
    v_bfe_u32 v9, v0, 3, 1
    v_lshlrev_b32 v9, 6, v9
    v_xor_b32 v1, v1, v9
    v_add_u32 v8, v8, v1
    v_add_u32 v8, 98304, v8
    v_mov_b32 v64, 0
    v_mov_b32 v65, 0
    v_mov_b32 v66, 0
    v_mov_b32 v67, 0
    v_mov_b32 v68, 0
    v_mov_b32 v69, 0
    v_mov_b32 v70, 0
    v_mov_b32 v71, 0
    v_mov_b32 v72, 0
    v_mov_b32 v73, 0
    v_mov_b32 v74, 0
    v_mov_b32 v75, 0
    v_mov_b32 v76, 0
    v_mov_b32 v77, 0
    v_mov_b32 v78, 0
    v_mov_b32 v79, 0
    v_mov_b32 v80, 0
    v_mov_b32 v81, 0
    v_mov_b32 v82, 0
    v_mov_b32 v83, 0
    v_mov_b32 v84, 0
    v_mov_b32 v85, 0
    v_mov_b32 v86, 0
    v_mov_b32 v87, 0
    v_mov_b32 v88, 0
    v_mov_b32 v89, 0
    v_mov_b32 v90, 0
    v_mov_b32 v91, 0
    v_mov_b32 v92, 0
    v_mov_b32 v93, 0
    v_mov_b32 v94, 0
    v_mov_b32 v95, 0
    v_mov_b32 v96, 0
    v_mov_b32 v97, 0
    v_mov_b32 v98, 0
    v_mov_b32 v99, 0
    v_mov_b32 v100, 0
    v_mov_b32 v101, 0
    v_mov_b32 v102, 0
    v_mov_b32 v103, 0
    v_mov_b32 v104, 0
    v_mov_b32 v105, 0
    v_mov_b32 v106, 0
    v_mov_b32 v107, 0
    v_mov_b32 v108, 0
    v_mov_b32 v109, 0
    v_mov_b32 v110, 0
    v_mov_b32 v111, 0
    v_mov_b32 v112, 0
    v_mov_b32 v113, 0
    v_mov_b32 v114, 0
    v_mov_b32 v115, 0
    v_mov_b32 v116, 0
    v_mov_b32 v117, 0
    v_mov_b32 v118, 0
    v_mov_b32 v119, 0
    v_mov_b32 v120, 0
    v_mov_b32 v121, 0
    v_mov_b32 v122, 0
    v_mov_b32 v123, 0
    v_mov_b32 v124, 0
    v_mov_b32 v125, 0
    v_mov_b32 v126, 0
    v_mov_b32 v127, 0
    s_waitcnt vmcnt(6)
    s_barrier
    ds_read_b128 v[16:19], v6 offset:0
    ds_read_b128 v[20:23], v6 offset:4096
    ds_read_b64_tr_b16 v[24:25], v8 offset:0
    ds_read_b64_tr_b16 v[26:27], v8 offset:512
    ds_read_b64_tr_b16 v[28:29], v8 offset:8192
    ds_read_b64_tr_b16 v[30:31], v8 offset:8704
    ds_read_b128 v[32:35], v7 offset:0
    ds_read_b128 v[36:39], v7 offset:4096
    ds_read_b64_tr_b16 v[40:41], v8 offset:2048
    ds_read_b64_tr_b16 v[42:43], v8 offset:2560
    ds_read_b64_tr_b16 v[44:45], v8 offset:10240
    ds_read_b64_tr_b16 v[46:47], v8 offset:10752
    s_waitcnt vmcnt(0)
    s_barrier
    s_waitcnt lgkmcnt(6)
    v_mfma_f32_32x32x16_bf16 v[64:79], v[24:27], v[16:19], v[64:79]
    s_add_u32 m0, s38, 131072
    s_nop 0
    buffer_load_dwordx4 v10, s[8:11], s30 offen lds
    v_mfma_f32_32x32x16_bf16 v[80:95], v[28:31], v[16:19], v[80:95]
    v_mfma_f32_32x32x16_bf16 v[96:111], v[24:27], v[20:23], v[96:111]
    s_add_u32 m0, s38, 132096
    s_nop 0
    buffer_load_dwordx4 v11, s[8:11], s30 offen lds
    s_add_u32 s30, s30, 196608
    s_cmp_eq_u32 s30, 1966080
    s_cselect_b32 s30, 0, s30
    v_mfma_f32_32x32x16_bf16 v[112:127], v[28:31], v[20:23], v[112:127]
    ds_read_b128 v[16:19], v14 offset:0
    ds_read_b128 v[20:23], v14 offset:4096
    ds_read_b64_tr_b16 v[24:25], v8 offset:4096
    ds_read_b64_tr_b16 v[26:27], v8 offset:4608
    ds_read_b64_tr_b16 v[28:29], v8 offset:12288
    ds_read_b64_tr_b16 v[30:31], v8 offset:12800
    s_waitcnt lgkmcnt(6)
    v_mfma_f32_32x32x16_bf16 v[64:79], v[40:43], v[32:35], v[64:79]
    s_add_u32 m0, s28, 65536
    s_nop 0
    buffer_load_dwordx4 v2, s[4:7], s29 offen lds
    v_mfma_f32_32x32x16_bf16 v[80:95], v[44:47], v[32:35], v[80:95]
    v_mfma_f32_32x32x16_bf16 v[96:111], v[40:43], v[36:39], v[96:111]
    s_add_u32 m0, s28, 66560
    s_nop 0
    buffer_load_dwordx4 v3, s[4:7], s29 offen lds
    v_mfma_f32_32x32x16_bf16 v[112:127], v[44:47], v[36:39], v[112:127]
    ds_read_b128 v[32:35], v15 offset:0
    ds_read_b128 v[36:39], v15 offset:4096
    ds_read_b64_tr_b16 v[40:41], v8 offset:6144
    ds_read_b64_tr_b16 v[42:43], v8 offset:6656
    ds_read_b64_tr_b16 v[44:45], v8 offset:14336
    ds_read_b64_tr_b16 v[46:47], v8 offset:14848
    s_waitcnt lgkmcnt(6)
    v_mfma_f32_32x32x16_bf16 v[64:79], v[24:27], v[16:19], v[64:79]
    s_add_u32 m0, s28, 67584
    s_nop 0
    buffer_load_dwordx4 v4, s[4:7], s29 offen lds
    v_mfma_f32_32x32x16_bf16 v[80:95], v[28:31], v[16:19], v[80:95]
    v_mfma_f32_32x32x16_bf16 v[96:111], v[24:27], v[20:23], v[96:111]
    s_add_u32 m0, s28, 68608
    s_nop 0
    buffer_load_dwordx4 v5, s[4:7], s29 offen lds
    s_add_u32 s29, s29, 128
    s_cmp_eq_u32 s29, 1280
    s_cselect_b32 s29, 0, s29
    v_mfma_f32_32x32x16_bf16 v[112:127], v[28:31], v[20:23], v[112:127]
    ds_read_b128 v[16:19], v6 offset:32768
    ds_read_b128 v[20:23], v6 offset:36864
    ds_read_b64_tr_b16 v[24:25], v8 offset:16384
    ds_read_b64_tr_b16 v[26:27], v8 offset:16896
    ds_read_b64_tr_b16 v[28:29], v8 offset:24576
    ds_read_b64_tr_b16 v[30:31], v8 offset:25088
    s_waitcnt lgkmcnt(6)
    v_mfma_f32_32x32x16_bf16 v[64:79], v[40:43], v[32:35], v[64:79]
    v_mfma_f32_32x32x16_bf16 v[80:95], v[44:47], v[32:35], v[80:95]
    v_mfma_f32_32x32x16_bf16 v[96:111], v[40:43], v[36:39], v[96:111]
    v_mfma_f32_32x32x16_bf16 v[112:127], v[44:47], v[36:39], v[112:127]
    ds_read_b128 v[32:35], v7 offset:32768
    ds_read_b128 v[36:39], v7 offset:36864
    ds_read_b64_tr_b16 v[40:41], v8 offset:18432
    ds_read_b64_tr_b16 v[42:43], v8 offset:18944
    ds_read_b64_tr_b16 v[44:45], v8 offset:26624
    ds_read_b64_tr_b16 v[46:47], v8 offset:27136
    s_waitcnt vmcnt(0)
    s_barrier
    s_waitcnt lgkmcnt(6)
    v_mfma_f32_32x32x16_bf16 v[64:79], v[24:27], v[16:19], v[64:79]
    s_add_u32 m0, s38, 98304
    s_nop 0
    buffer_load_dwordx4 v10, s[8:11], s30 offen lds
    v_mfma_f32_32x32x16_bf16 v[80:95], v[28:31], v[16:19], v[80:95]
    v_mfma_f32_32x32x16_bf16 v[96:111], v[24:27], v[20:23], v[96:111]
    s_add_u32 m0, s38, 99328
    s_nop 0
    buffer_load_dwordx4 v11, s[8:11], s30 offen lds
    s_add_u32 s30, s30, 196608
    s_cmp_eq_u32 s30, 1966080
    s_cselect_b32 s30, 0, s30
    v_mfma_f32_32x32x16_bf16 v[112:127], v[28:31], v[20:23], v[112:127]
    ds_read_b128 v[16:19], v14 offset:32768
    ds_read_b128 v[20:23], v14 offset:36864
    ds_read_b64_tr_b16 v[24:25], v8 offset:20480
    ds_read_b64_tr_b16 v[26:27], v8 offset:20992
    ds_read_b64_tr_b16 v[28:29], v8 offset:28672
    ds_read_b64_tr_b16 v[30:31], v8 offset:29184
    s_waitcnt lgkmcnt(6)
    v_mfma_f32_32x32x16_bf16 v[64:79], v[40:43], v[32:35], v[64:79]
    s_add_u32 m0, s28, 0
    s_nop 0
    buffer_load_dwordx4 v2, s[4:7], s29 offen lds
    v_mfma_f32_32x32x16_bf16 v[80:95], v[44:47], v[32:35], v[80:95]
    v_mfma_f32_32x32x16_bf16 v[96:111], v[40:43], v[36:39], v[96:111]
    s_add_u32 m0, s28, 1024
    s_nop 0
    buffer_load_dwordx4 v3, s[4:7], s29 offen lds
    v_mfma_f32_32x32x16_bf16 v[112:127], v[44:47], v[36:39], v[112:127]
    ds_read_b128 v[32:35], v15 offset:32768
    ds_read_b128 v[36:39], v15 offset:36864
    ds_read_b64_tr_b16 v[40:41], v8 offset:22528
    ds_read_b64_tr_b16 v[42:43], v8 offset:23040
    ds_read_b64_tr_b16 v[44:45], v8 offset:30720
    ds_read_b64_tr_b16 v[46:47], v8 offset:31232
    s_waitcnt lgkmcnt(6)
    v_mfma_f32_32x32x16_bf16 v[64:79], v[24:27], v[16:19], v[64:79]
    s_add_u32 m0, s28, 2048
    s_nop 0
    buffer_load_dwordx4 v4, s[4:7], s29 offen lds
    v_mfma_f32_32x32x16_bf16 v[80:95], v[28:31], v[16:19], v[80:95]
    v_mfma_f32_32x32x16_bf16 v[96:111], v[24:27], v[20:23], v[96:111]
    s_add_u32 m0, s28, 3072
    s_nop 0
    buffer_load_dwordx4 v5, s[4:7], s29 offen lds
    s_add_u32 s29, s29, 128
    s_cmp_eq_u32 s29, 1280
    s_cselect_b32 s29, 0, s29
    v_mfma_f32_32x32x16_bf16 v[112:127], v[28:31], v[20:23], v[112:127]
    ds_read_b128 v[16:19], v48 offset:0
    ds_read_b128 v[20:23], v48 offset:4096
    ds_read_b64_tr_b16 v[24:25], v8 offset:32768
    ds_read_b64_tr_b16 v[26:27], v8 offset:33280
    ds_read_b64_tr_b16 v[28:29], v8 offset:40960
    ds_read_b64_tr_b16 v[30:31], v8 offset:41472
    s_waitcnt lgkmcnt(6)
    v_mfma_f32_32x32x16_bf16 v[64:79], v[40:43], v[32:35], v[64:79]
    v_mfma_f32_32x32x16_bf16 v[80:95], v[44:47], v[32:35], v[80:95]
    v_mfma_f32_32x32x16_bf16 v[96:111], v[40:43], v[36:39], v[96:111]
    v_mfma_f32_32x32x16_bf16 v[112:127], v[44:47], v[36:39], v[112:127]
    ds_read_b128 v[32:35], v49 offset:0
    ds_read_b128 v[36:39], v49 offset:4096
    ds_read_b64_tr_b16 v[40:41], v8 offset:34816
    ds_read_b64_tr_b16 v[42:43], v8 offset:35328
    ds_read_b64_tr_b16 v[44:45], v8 offset:43008
    ds_read_b64_tr_b16 v[46:47], v8 offset:43520
    s_waitcnt vmcnt(0)
    s_barrier
    s_waitcnt lgkmcnt(6)
    v_mfma_f32_32x32x16_bf16 v[64:79], v[24:27], v[16:19], v[64:79]
    s_add_u32 m0, s38, 114688
    s_nop 0
    buffer_load_dwordx4 v10, s[8:11], s30 offen lds
    v_mfma_f32_32x32x16_bf16 v[80:95], v[28:31], v[16:19], v[80:95]
    v_mfma_f32_32x32x16_bf16 v[96:111], v[24:27], v[20:23], v[96:111]
    s_add_u32 m0, s38, 115712
    s_nop 0
    buffer_load_dwordx4 v11, s[8:11], s30 offen lds
    s_add_u32 s30, s30, 196608
    s_cmp_eq_u32 s30, 1966080
    s_cselect_b32 s30, 0, s30
    v_mfma_f32_32x32x16_bf16 v[112:127], v[28:31], v[20:23], v[112:127]
    ds_read_b128 v[16:19], v50 offset:0
    ds_read_b128 v[20:23], v50 offset:4096
    ds_read_b64_tr_b16 v[24:25], v8 offset:36864
    ds_read_b64_tr_b16 v[26:27], v8 offset:37376
    ds_read_b64_tr_b16 v[28:29], v8 offset:45056
    ds_read_b64_tr_b16 v[30:31], v8 offset:45568
    s_waitcnt lgkmcnt(6)
    v_mfma_f32_32x32x16_bf16 v[64:79], v[40:43], v[32:35], v[64:79]
    s_add_u32 m0, s28, 32768
    s_nop 0
    buffer_load_dwordx4 v2, s[4:7], s29 offen lds
    v_mfma_f32_32x32x16_bf16 v[80:95], v[44:47], v[32:35], v[80:95]
    v_mfma_f32_32x32x16_bf16 v[96:111], v[40:43], v[36:39], v[96:111]
    s_add_u32 m0, s28, 33792
    s_nop 0
    buffer_load_dwordx4 v3, s[4:7], s29 offen lds
    v_mfma_f32_32x32x16_bf16 v[112:127], v[44:47], v[36:39], v[112:127]
    ds_read_b128 v[32:35], v51 offset:0
    ds_read_b128 v[36:39], v51 offset:4096
    ds_read_b64_tr_b16 v[40:41], v8 offset:38912
    ds_read_b64_tr_b16 v[42:43], v8 offset:39424
    ds_read_b64_tr_b16 v[44:45], v8 offset:47104
    ds_read_b64_tr_b16 v[46:47], v8 offset:47616
    s_waitcnt lgkmcnt(6)
    v_mfma_f32_32x32x16_bf16 v[64:79], v[24:27], v[16:19], v[64:79]
    s_add_u32 m0, s28, 34816
    s_nop 0
    buffer_load_dwordx4 v4, s[4:7], s29 offen lds
    v_mfma_f32_32x32x16_bf16 v[80:95], v[28:31], v[16:19], v[80:95]
    v_mfma_f32_32x32x16_bf16 v[96:111], v[24:27], v[20:23], v[96:111]
    s_add_u32 m0, s28, 35840
    s_nop 0
    buffer_load_dwordx4 v5, s[4:7], s29 offen lds
    s_add_u32 s29, s29, 128
    s_cmp_eq_u32 s29, 1280
    s_cselect_b32 s29, 0, s29
    v_mfma_f32_32x32x16_bf16 v[112:127], v[28:31], v[20:23], v[112:127]
    ds_read_b128 v[16:19], v6 offset:0
    ds_read_b128 v[20:23], v6 offset:4096
    ds_read_b64_tr_b16 v[24:25], v8 offset:0
    ds_read_b64_tr_b16 v[26:27], v8 offset:512
    ds_read_b64_tr_b16 v[28:29], v8 offset:8192
    ds_read_b64_tr_b16 v[30:31], v8 offset:8704
    s_waitcnt lgkmcnt(6)
    v_mfma_f32_32x32x16_bf16 v[64:79], v[40:43], v[32:35], v[64:79]
    v_mfma_f32_32x32x16_bf16 v[80:95], v[44:47], v[32:35], v[80:95]
    v_mfma_f32_32x32x16_bf16 v[96:111], v[40:43], v[36:39], v[96:111]
    v_mfma_f32_32x32x16_bf16 v[112:127], v[44:47], v[36:39], v[112:127]
    ds_read_b128 v[32:35], v7 offset:0
    ds_read_b128 v[36:39], v7 offset:4096
    ds_read_b64_tr_b16 v[40:41], v8 offset:2048
    ds_read_b64_tr_b16 v[42:43], v8 offset:2560
    ds_read_b64_tr_b16 v[44:45], v8 offset:10240
    ds_read_b64_tr_b16 v[46:47], v8 offset:10752
    s_waitcnt vmcnt(0)
    s_barrier
    s_waitcnt lgkmcnt(6)
    v_mfma_f32_32x32x16_bf16 v[64:79], v[24:27], v[16:19], v[64:79]
    s_add_u32 m0, s38, 131072
    s_nop 0
    buffer_load_dwordx4 v10, s[8:11], s30 offen lds
    v_mfma_f32_32x32x16_bf16 v[80:95], v[28:31], v[16:19], v[80:95]
    v_mfma_f32_32x32x16_bf16 v[96:111], v[24:27], v[20:23], v[96:111]
    s_add_u32 m0, s38, 132096
    s_nop 0
    buffer_load_dwordx4 v11, s[8:11], s30 offen lds
    s_add_u32 s30, s30, 196608
    s_cmp_eq_u32 s30, 1966080
    s_cselect_b32 s30, 0, s30
    v_mfma_f32_32x32x16_bf16 v[112:127], v[28:31], v[20:23], v[112:127]
    ds_read_b128 v[16:19], v14 offset:0
    ds_read_b128 v[20:23], v14 offset:4096
    ds_read_b64_tr_b16 v[24:25], v8 offset:4096
    ds_read_b64_tr_b16 v[26:27], v8 offset:4608
    ds_read_b64_tr_b16 v[28:29], v8 offset:12288
    ds_read_b64_tr_b16 v[30:31], v8 offset:12800
    s_waitcnt lgkmcnt(6)
    v_mfma_f32_32x32x16_bf16 v[64:79], v[40:43], v[32:35], v[64:79]
    s_add_u32 m0, s28, 65536
    s_nop 0
    buffer_load_dwordx4 v2, s[4:7], s29 offen lds
    v_mfma_f32_32x32x16_bf16 v[80:95], v[44:47], v[32:35], v[80:95]
    v_mfma_f32_32x32x16_bf16 v[96:111], v[40:43], v[36:39], v[96:111]
    s_add_u32 m0, s28, 66560
    s_nop 0
    buffer_load_dwordx4 v3, s[4:7], s29 offen lds
    v_mfma_f32_32x32x16_bf16 v[112:127], v[44:47], v[36:39], v[112:127]
    ds_read_b128 v[32:35], v15 offset:0
    ds_read_b128 v[36:39], v15 offset:4096
    ds_read_b64_tr_b16 v[40:41], v8 offset:6144
    ds_read_b64_tr_b16 v[42:43], v8 offset:6656
    ds_read_b64_tr_b16 v[44:45], v8 offset:14336
    ds_read_b64_tr_b16 v[46:47], v8 offset:14848
    s_waitcnt lgkmcnt(6)
    v_mfma_f32_32x32x16_bf16 v[64:79], v[24:27], v[16:19], v[64:79]
    s_add_u32 m0, s28, 67584
    s_nop 0
    buffer_load_dwordx4 v4, s[4:7], s29 offen lds
    v_mfma_f32_32x32x16_bf16 v[80:95], v[28:31], v[16:19], v[80:95]
    v_mfma_f32_32x32x16_bf16 v[96:111], v[24:27], v[20:23], v[96:111]
    s_add_u32 m0, s28, 68608
    s_nop 0
    buffer_load_dwordx4 v5, s[4:7], s29 offen lds
    s_add_u32 s29, s29, 128
    s_cmp_eq_u32 s29, 1280
    s_cselect_b32 s29, 0, s29
    v_mfma_f32_32x32x16_bf16 v[112:127], v[28:31], v[20:23], v[112:127]
    ds_read_b128 v[16:19], v6 offset:32768
    ds_read_b128 v[20:23], v6 offset:36864
    ds_read_b64_tr_b16 v[24:25], v8 offset:16384
    ds_read_b64_tr_b16 v[26:27], v8 offset:16896
    ds_read_b64_tr_b16 v[28:29], v8 offset:24576
    ds_read_b64_tr_b16 v[30:31], v8 offset:25088
    s_waitcnt lgkmcnt(6)
    v_mfma_f32_32x32x16_bf16 v[64:79], v[40:43], v[32:35], v[64:79]
    v_mfma_f32_32x32x16_bf16 v[80:95], v[44:47], v[32:35], v[80:95]
    v_mfma_f32_32x32x16_bf16 v[96:111], v[40:43], v[36:39], v[96:111]
    v_mfma_f32_32x32x16_bf16 v[112:127], v[44:47], v[36:39], v[112:127]
    ds_read_b128 v[32:35], v7 offset:32768
    ds_read_b128 v[36:39], v7 offset:36864
    ds_read_b64_tr_b16 v[40:41], v8 offset:18432
    ds_read_b64_tr_b16 v[42:43], v8 offset:18944
    ds_read_b64_tr_b16 v[44:45], v8 offset:26624
    ds_read_b64_tr_b16 v[46:47], v8 offset:27136
    s_waitcnt vmcnt(0)
    s_barrier
    s_waitcnt lgkmcnt(6)
    v_mfma_f32_32x32x16_bf16 v[64:79], v[24:27], v[16:19], v[64:79]
    s_add_u32 m0, s38, 98304
    s_nop 0
    buffer_load_dwordx4 v10, s[8:11], s30 offen lds
    v_mfma_f32_32x32x16_bf16 v[80:95], v[28:31], v[16:19], v[80:95]
    v_mfma_f32_32x32x16_bf16 v[96:111], v[24:27], v[20:23], v[96:111]
    s_add_u32 m0, s38, 99328
    s_nop 0
    buffer_load_dwordx4 v11, s[8:11], s30 offen lds
    s_add_u32 s30, s30, 196608
    s_cmp_eq_u32 s30, 1966080
    s_cselect_b32 s30, 0, s30
    v_mfma_f32_32x32x16_bf16 v[112:127], v[28:31], v[20:23], v[112:127]
    ds_read_b128 v[16:19], v14 offset:32768
    ds_read_b128 v[20:23], v14 offset:36864
    ds_read_b64_tr_b16 v[24:25], v8 offset:20480
    ds_read_b64_tr_b16 v[26:27], v8 offset:20992
    ds_read_b64_tr_b16 v[28:29], v8 offset:28672
    ds_read_b64_tr_b16 v[30:31], v8 offset:29184
    s_waitcnt lgkmcnt(6)
    v_mfma_f32_32x32x16_bf16 v[64:79], v[40:43], v[32:35], v[64:79]
    s_add_u32 m0, s28, 0
    s_nop 0
    buffer_load_dwordx4 v2, s[4:7], s29 offen lds
    v_mfma_f32_32x32x16_bf16 v[80:95], v[44:47], v[32:35], v[80:95]
    v_mfma_f32_32x32x16_bf16 v[96:111], v[40:43], v[36:39], v[96:111]
    s_add_u32 m0, s28, 1024
    s_nop 0
    buffer_load_dwordx4 v3, s[4:7], s29 offen lds
    v_mfma_f32_32x32x16_bf16 v[112:127], v[44:47], v[36:39], v[112:127]
    ds_read_b128 v[32:35], v15 offset:32768
    ds_read_b128 v[36:39], v15 offset:36864
    ds_read_b64_tr_b16 v[40:41], v8 offset:22528
    ds_read_b64_tr_b16 v[42:43], v8 offset:23040
    ds_read_b64_tr_b16 v[44:45], v8 offset:30720
    ds_read_b64_tr_b16 v[46:47], v8 offset:31232
    s_waitcnt lgkmcnt(6)
    v_mfma_f32_32x32x16_bf16 v[64:79], v[24:27], v[16:19], v[64:79]
    s_add_u32 m0, s28, 2048
    s_nop 0
    buffer_load_dwordx4 v4, s[4:7], s29 offen lds
    v_mfma_f32_32x32x16_bf16 v[80:95], v[28:31], v[16:19], v[80:95]
    v_mfma_f32_32x32x16_bf16 v[96:111], v[24:27], v[20:23], v[96:111]
    s_add_u32 m0, s28, 3072
    s_nop 0
    buffer_load_dwordx4 v5, s[4:7], s29 offen lds
    s_add_u32 s29, s29, 128
    s_cmp_eq_u32 s29, 1280
    s_cselect_b32 s29, 0, s29
    v_mfma_f32_32x32x16_bf16 v[112:127], v[28:31], v[20:23], v[112:127]
    ds_read_b128 v[16:19], v48 offset:0
    ds_read_b128 v[20:23], v48 offset:4096
    ds_read_b64_tr_b16 v[24:25], v8 offset:32768
    ds_read_b64_tr_b16 v[26:27], v8 offset:33280
    ds_read_b64_tr_b16 v[28:29], v8 offset:40960
    ds_read_b64_tr_b16 v[30:31], v8 offset:41472
    s_waitcnt lgkmcnt(6)
    v_mfma_f32_32x32x16_bf16 v[64:79], v[40:43], v[32:35], v[64:79]
    v_mfma_f32_32x32x16_bf16 v[80:95], v[44:47], v[32:35], v[80:95]
    v_mfma_f32_32x32x16_bf16 v[96:111], v[40:43], v[36:39], v[96:111]
    v_mfma_f32_32x32x16_bf16 v[112:127], v[44:47], v[36:39], v[112:127]
    ds_read_b128 v[32:35], v49 offset:0
    ds_read_b128 v[36:39], v49 offset:4096
    ds_read_b64_tr_b16 v[40:41], v8 offset:34816
    ds_read_b64_tr_b16 v[42:43], v8 offset:35328
    ds_read_b64_tr_b16 v[44:45], v8 offset:43008
    ds_read_b64_tr_b16 v[46:47], v8 offset:43520
    s_waitcnt vmcnt(0)
    s_barrier
    s_waitcnt lgkmcnt(6)
    v_mfma_f32_32x32x16_bf16 v[64:79], v[24:27], v[16:19], v[64:79]
    s_add_u32 m0, s38, 114688
    s_nop 0
    buffer_load_dwordx4 v10, s[8:11], s30 offen lds
    v_mfma_f32_32x32x16_bf16 v[80:95], v[28:31], v[16:19], v[80:95]
    v_mfma_f32_32x32x16_bf16 v[96:111], v[24:27], v[20:23], v[96:111]
    s_add_u32 m0, s38, 115712
    s_nop 0
    buffer_load_dwordx4 v11, s[8:11], s30 offen lds
    s_add_u32 s30, s30, 196608
    s_cmp_eq_u32 s30, 1966080
    s_cselect_b32 s30, 0, s30
    v_mfma_f32_32x32x16_bf16 v[112:127], v[28:31], v[20:23], v[112:127]
    ds_read_b128 v[16:19], v50 offset:0
    ds_read_b128 v[20:23], v50 offset:4096
    ds_read_b64_tr_b16 v[24:25], v8 offset:36864
    ds_read_b64_tr_b16 v[26:27], v8 offset:37376
    ds_read_b64_tr_b16 v[28:29], v8 offset:45056
    ds_read_b64_tr_b16 v[30:31], v8 offset:45568
    s_waitcnt lgkmcnt(6)
    v_mfma_f32_32x32x16_bf16 v[64:79], v[40:43], v[32:35], v[64:79]
    s_add_u32 m0, s28, 32768
    s_nop 0
    buffer_load_dwordx4 v2, s[4:7], s29 offen lds
    v_mfma_f32_32x32x16_bf16 v[80:95], v[44:47], v[32:35], v[80:95]
    v_mfma_f32_32x32x16_bf16 v[96:111], v[40:43], v[36:39], v[96:111]
    s_add_u32 m0, s28, 33792
    s_nop 0
    buffer_load_dwordx4 v3, s[4:7], s29 offen lds
    v_mfma_f32_32x32x16_bf16 v[112:127], v[44:47], v[36:39], v[112:127]
    ds_read_b128 v[32:35], v51 offset:0
    ds_read_b128 v[36:39], v51 offset:4096
    ds_read_b64_tr_b16 v[40:41], v8 offset:38912
    ds_read_b64_tr_b16 v[42:43], v8 offset:39424
    ds_read_b64_tr_b16 v[44:45], v8 offset:47104
    ds_read_b64_tr_b16 v[46:47], v8 offset:47616
    s_waitcnt lgkmcnt(6)
    v_mfma_f32_32x32x16_bf16 v[64:79], v[24:27], v[16:19], v[64:79]
    s_add_u32 m0, s28, 34816
    s_nop 0
    buffer_load_dwordx4 v4, s[4:7], s29 offen lds
    v_mfma_f32_32x32x16_bf16 v[80:95], v[28:31], v[16:19], v[80:95]
    v_mfma_f32_32x32x16_bf16 v[96:111], v[24:27], v[20:23], v[96:111]
    s_add_u32 m0, s28, 35840
    s_nop 0
    buffer_load_dwordx4 v5, s[4:7], s29 offen lds
    s_add_u32 s29, s29, 128
    s_cmp_eq_u32 s29, 1280
    s_cselect_b32 s29, 0, s29
    v_mfma_f32_32x32x16_bf16 v[112:127], v[28:31], v[20:23], v[112:127]
    ds_read_b128 v[16:19], v6 offset:0
    ds_read_b128 v[20:23], v6 offset:4096
    ds_read_b64_tr_b16 v[24:25], v8 offset:0
    ds_read_b64_tr_b16 v[26:27], v8 offset:512
    ds_read_b64_tr_b16 v[28:29], v8 offset:8192
    ds_read_b64_tr_b16 v[30:31], v8 offset:8704
    s_waitcnt lgkmcnt(6)
    v_mfma_f32_32x32x16_bf16 v[64:79], v[40:43], v[32:35], v[64:79]
    v_mfma_f32_32x32x16_bf16 v[80:95], v[44:47], v[32:35], v[80:95]
    v_mfma_f32_32x32x16_bf16 v[96:111], v[40:43], v[36:39], v[96:111]
    v_mfma_f32_32x32x16_bf16 v[112:127], v[44:47], v[36:39], v[112:127]
    ds_read_b128 v[32:35], v7 offset:0
    ds_read_b128 v[36:39], v7 offset:4096
    ds_read_b64_tr_b16 v[40:41], v8 offset:2048
    ds_read_b64_tr_b16 v[42:43], v8 offset:2560
    ds_read_b64_tr_b16 v[44:45], v8 offset:10240
    ds_read_b64_tr_b16 v[46:47], v8 offset:10752
    s_waitcnt vmcnt(0)
    s_barrier
    s_waitcnt lgkmcnt(6)
    v_mfma_f32_32x32x16_bf16 v[64:79], v[24:27], v[16:19], v[64:79]
    s_add_u32 m0, s38, 131072
    s_nop 0
    buffer_load_dwordx4 v10, s[8:11], s30 offen lds
    v_mfma_f32_32x32x16_bf16 v[80:95], v[28:31], v[16:19], v[80:95]
    v_mfma_f32_32x32x16_bf16 v[96:111], v[24:27], v[20:23], v[96:111]
    s_add_u32 m0, s38, 132096
    s_nop 0
    buffer_load_dwordx4 v11, s[8:11], s30 offen lds
    s_add_u32 s30, s30, 196608
    s_cmp_eq_u32 s30, 1966080
    s_cselect_b32 s30, 0, s30
    v_mfma_f32_32x32x16_bf16 v[112:127], v[28:31], v[20:23], v[112:127]
    ds_read_b128 v[16:19], v14 offset:0
    ds_read_b128 v[20:23], v14 offset:4096
    ds_read_b64_tr_b16 v[24:25], v8 offset:4096
    ds_read_b64_tr_b16 v[26:27], v8 offset:4608
    ds_read_b64_tr_b16 v[28:29], v8 offset:12288
    ds_read_b64_tr_b16 v[30:31], v8 offset:12800
    s_waitcnt lgkmcnt(6)
    v_mfma_f32_32x32x16_bf16 v[64:79], v[40:43], v[32:35], v[64:79]
    s_add_u32 m0, s28, 65536
    s_nop 0
    buffer_load_dwordx4 v2, s[4:7], s29 offen lds
    v_mfma_f32_32x32x16_bf16 v[80:95], v[44:47], v[32:35], v[80:95]
    v_mfma_f32_32x32x16_bf16 v[96:111], v[40:43], v[36:39], v[96:111]
    s_add_u32 m0, s28, 66560
    s_nop 0
    buffer_load_dwordx4 v3, s[4:7], s29 offen lds
    v_mfma_f32_32x32x16_bf16 v[112:127], v[44:47], v[36:39], v[112:127]
    ds_read_b128 v[32:35], v15 offset:0
    ds_read_b128 v[36:39], v15 offset:4096
    ds_read_b64_tr_b16 v[40:41], v8 offset:6144
    ds_read_b64_tr_b16 v[42:43], v8 offset:6656
    ds_read_b64_tr_b16 v[44:45], v8 offset:14336
    ds_read_b64_tr_b16 v[46:47], v8 offset:14848
    s_waitcnt lgkmcnt(6)
    v_mfma_f32_32x32x16_bf16 v[64:79], v[24:27], v[16:19], v[64:79]
    s_add_u32 m0, s28, 67584
    s_nop 0
    buffer_load_dwordx4 v4, s[4:7], s29 offen lds
    v_mfma_f32_32x32x16_bf16 v[80:95], v[28:31], v[16:19], v[80:95]
    v_mfma_f32_32x32x16_bf16 v[96:111], v[24:27], v[20:23], v[96:111]
    s_add_u32 m0, s28, 68608
    s_nop 0
    buffer_load_dwordx4 v5, s[4:7], s29 offen lds
    s_add_u32 s29, s29, 128
    s_cmp_eq_u32 s29, 1280
    s_cselect_b32 s29, 0, s29
    v_mfma_f32_32x32x16_bf16 v[112:127], v[28:31], v[20:23], v[112:127]
    ds_read_b128 v[16:19], v6 offset:32768
    ds_read_b128 v[20:23], v6 offset:36864
    ds_read_b64_tr_b16 v[24:25], v8 offset:16384
    ds_read_b64_tr_b16 v[26:27], v8 offset:16896
    ds_read_b64_tr_b16 v[28:29], v8 offset:24576
    ds_read_b64_tr_b16 v[30:31], v8 offset:25088
    s_waitcnt lgkmcnt(6)
    v_mfma_f32_32x32x16_bf16 v[64:79], v[40:43], v[32:35], v[64:79]
    v_mfma_f32_32x32x16_bf16 v[80:95], v[44:47], v[32:35], v[80:95]
    v_mfma_f32_32x32x16_bf16 v[96:111], v[40:43], v[36:39], v[96:111]
    v_mfma_f32_32x32x16_bf16 v[112:127], v[44:47], v[36:39], v[112:127]
    ds_read_b128 v[32:35], v7 offset:32768
    ds_read_b128 v[36:39], v7 offset:36864
    ds_read_b64_tr_b16 v[40:41], v8 offset:18432
    ds_read_b64_tr_b16 v[42:43], v8 offset:18944
    ds_read_b64_tr_b16 v[44:45], v8 offset:26624
    ds_read_b64_tr_b16 v[46:47], v8 offset:27136
    s_waitcnt vmcnt(0)
    s_barrier
    s_waitcnt lgkmcnt(6)
    v_mfma_f32_32x32x16_bf16 v[64:79], v[24:27], v[16:19], v[64:79]
    s_add_u32 m0, s38, 98304
    s_nop 0
    buffer_load_dwordx4 v10, s[8:11], s30 offen lds
    v_mfma_f32_32x32x16_bf16 v[80:95], v[28:31], v[16:19], v[80:95]
    v_mfma_f32_32x32x16_bf16 v[96:111], v[24:27], v[20:23], v[96:111]
    s_add_u32 m0, s38, 99328
    s_nop 0
    buffer_load_dwordx4 v11, s[8:11], s30 offen lds
    s_add_u32 s30, s30, 196608
    s_cmp_eq_u32 s30, 1966080
    s_cselect_b32 s30, 0, s30
    v_mfma_f32_32x32x16_bf16 v[112:127], v[28:31], v[20:23], v[112:127]
    ds_read_b128 v[16:19], v14 offset:32768
    ds_read_b128 v[20:23], v14 offset:36864
    ds_read_b64_tr_b16 v[24:25], v8 offset:20480
    ds_read_b64_tr_b16 v[26:27], v8 offset:20992
    ds_read_b64_tr_b16 v[28:29], v8 offset:28672
    ds_read_b64_tr_b16 v[30:31], v8 offset:29184
    s_waitcnt lgkmcnt(6)
    v_mfma_f32_32x32x16_bf16 v[64:79], v[40:43], v[32:35], v[64:79]
    s_add_u32 m0, s28, 0
    s_nop 0
    buffer_load_dwordx4 v2, s[4:7], s29 offen lds
    v_mfma_f32_32x32x16_bf16 v[80:95], v[44:47], v[32:35], v[80:95]
    v_mfma_f32_32x32x16_bf16 v[96:111], v[40:43], v[36:39], v[96:111]
    s_add_u32 m0, s28, 1024
    s_nop 0
    buffer_load_dwordx4 v3, s[4:7], s29 offen lds
    v_mfma_f32_32x32x16_bf16 v[112:127], v[44:47], v[36:39], v[112:127]
    ds_read_b128 v[32:35], v15 offset:32768
    ds_read_b128 v[36:39], v15 offset:36864
    ds_read_b64_tr_b16 v[40:41], v8 offset:22528
    ds_read_b64_tr_b16 v[42:43], v8 offset:23040
    ds_read_b64_tr_b16 v[44:45], v8 offset:30720
    ds_read_b64_tr_b16 v[46:47], v8 offset:31232
    s_waitcnt lgkmcnt(6)
    v_mfma_f32_32x32x16_bf16 v[64:79], v[24:27], v[16:19], v[64:79]
    s_add_u32 m0, s28, 2048
    s_nop 0
    buffer_load_dwordx4 v4, s[4:7], s29 offen lds
    v_mfma_f32_32x32x16_bf16 v[80:95], v[28:31], v[16:19], v[80:95]
    v_mfma_f32_32x32x16_bf16 v[96:111], v[24:27], v[20:23], v[96:111]
    s_add_u32 m0, s28, 3072
    s_nop 0
    buffer_load_dwordx4 v5, s[4:7], s29 offen lds
    s_add_u32 s29, s29, 128
    s_cmp_eq_u32 s29, 1280
    s_cselect_b32 s29, 0, s29
    v_mfma_f32_32x32x16_bf16 v[112:127], v[28:31], v[20:23], v[112:127]
    ds_read_b128 v[16:19], v48 offset:0
    ds_read_b128 v[20:23], v48 offset:4096
    ds_read_b64_tr_b16 v[24:25], v8 offset:32768
    ds_read_b64_tr_b16 v[26:27], v8 offset:33280
    ds_read_b64_tr_b16 v[28:29], v8 offset:40960
    ds_read_b64_tr_b16 v[30:31], v8 offset:41472
    s_waitcnt lgkmcnt(6)
    v_mfma_f32_32x32x16_bf16 v[64:79], v[40:43], v[32:35], v[64:79]
    v_mfma_f32_32x32x16_bf16 v[80:95], v[44:47], v[32:35], v[80:95]
    v_mfma_f32_32x32x16_bf16 v[96:111], v[40:43], v[36:39], v[96:111]
    v_mfma_f32_32x32x16_bf16 v[112:127], v[44:47], v[36:39], v[112:127]
    ds_read_b128 v[32:35], v49 offset:0
    ds_read_b128 v[36:39], v49 offset:4096
    ds_read_b64_tr_b16 v[40:41], v8 offset:34816
    ds_read_b64_tr_b16 v[42:43], v8 offset:35328
    ds_read_b64_tr_b16 v[44:45], v8 offset:43008
    ds_read_b64_tr_b16 v[46:47], v8 offset:43520
    s_waitcnt vmcnt(0)
    s_barrier
    s_waitcnt lgkmcnt(6)
    v_mfma_f32_32x32x16_bf16 v[64:79], v[24:27], v[16:19], v[64:79]
    v_mfma_f32_32x32x16_bf16 v[80:95], v[28:31], v[16:19], v[80:95]
    v_mfma_f32_32x32x16_bf16 v[96:111], v[24:27], v[20:23], v[96:111]
    v_mfma_f32_32x32x16_bf16 v[112:127], v[28:31], v[20:23], v[112:127]
    ds_read_b128 v[16:19], v50 offset:0
    ds_read_b128 v[20:23], v50 offset:4096
    ds_read_b64_tr_b16 v[24:25], v8 offset:36864
    ds_read_b64_tr_b16 v[26:27], v8 offset:37376
    ds_read_b64_tr_b16 v[28:29], v8 offset:45056
    ds_read_b64_tr_b16 v[30:31], v8 offset:45568
    s_waitcnt lgkmcnt(6)
    v_mfma_f32_32x32x16_bf16 v[64:79], v[40:43], v[32:35], v[64:79]
    v_mfma_f32_32x32x16_bf16 v[80:95], v[44:47], v[32:35], v[80:95]
    v_mfma_f32_32x32x16_bf16 v[96:111], v[40:43], v[36:39], v[96:111]
    v_mfma_f32_32x32x16_bf16 v[112:127], v[44:47], v[36:39], v[112:127]
    ds_read_b128 v[32:35], v51 offset:0
    ds_read_b128 v[36:39], v51 offset:4096
    ds_read_b64_tr_b16 v[40:41], v8 offset:38912
    ds_read_b64_tr_b16 v[42:43], v8 offset:39424
    ds_read_b64_tr_b16 v[44:45], v8 offset:47104
    ds_read_b64_tr_b16 v[46:47], v8 offset:47616
    s_waitcnt lgkmcnt(6)
    v_mfma_f32_32x32x16_bf16 v[64:79], v[24:27], v[16:19], v[64:79]
    v_mfma_f32_32x32x16_bf16 v[80:95], v[28:31], v[16:19], v[80:95]
    v_mfma_f32_32x32x16_bf16 v[96:111], v[24:27], v[20:23], v[96:111]
    v_mfma_f32_32x32x16_bf16 v[112:127], v[28:31], v[20:23], v[112:127]
    ds_read_b128 v[16:19], v6 offset:0
    ds_read_b128 v[20:23], v6 offset:4096
    ds_read_b64_tr_b16 v[24:25], v8 offset:0
    ds_read_b64_tr_b16 v[26:27], v8 offset:512
    ds_read_b64_tr_b16 v[28:29], v8 offset:8192
    ds_read_b64_tr_b16 v[30:31], v8 offset:8704
    s_waitcnt lgkmcnt(6)
    v_mfma_f32_32x32x16_bf16 v[64:79], v[40:43], v[32:35], v[64:79]
    v_mfma_f32_32x32x16_bf16 v[80:95], v[44:47], v[32:35], v[80:95]
    v_mfma_f32_32x32x16_bf16 v[96:111], v[40:43], v[36:39], v[96:111]
    v_mfma_f32_32x32x16_bf16 v[112:127], v[44:47], v[36:39], v[112:127]
    ds_read_b128 v[32:35], v7 offset:0
    ds_read_b128 v[36:39], v7 offset:4096
    ds_read_b64_tr_b16 v[40:41], v8 offset:2048
    ds_read_b64_tr_b16 v[42:43], v8 offset:2560
    ds_read_b64_tr_b16 v[44:45], v8 offset:10240
    ds_read_b64_tr_b16 v[46:47], v8 offset:10752
    s_waitcnt lgkmcnt(6)
    v_mfma_f32_32x32x16_bf16 v[64:79], v[24:27], v[16:19], v[64:79]
    v_mfma_f32_32x32x16_bf16 v[80:95], v[28:31], v[16:19], v[80:95]
    v_mfma_f32_32x32x16_bf16 v[96:111], v[24:27], v[20:23], v[96:111]
    v_mfma_f32_32x32x16_bf16 v[112:127], v[28:31], v[20:23], v[112:127]
    ds_read_b128 v[16:19], v14 offset:0
    ds_read_b128 v[20:23], v14 offset:4096
    ds_read_b64_tr_b16 v[24:25], v8 offset:4096
    ds_read_b64_tr_b16 v[26:27], v8 offset:4608
    ds_read_b64_tr_b16 v[28:29], v8 offset:12288
    ds_read_b64_tr_b16 v[30:31], v8 offset:12800
    s_waitcnt lgkmcnt(6)
    v_mfma_f32_32x32x16_bf16 v[64:79], v[40:43], v[32:35], v[64:79]
    v_mfma_f32_32x32x16_bf16 v[80:95], v[44:47], v[32:35], v[80:95]
    v_mfma_f32_32x32x16_bf16 v[96:111], v[40:43], v[36:39], v[96:111]
    v_mfma_f32_32x32x16_bf16 v[112:127], v[44:47], v[36:39], v[112:127]
    ds_read_b128 v[32:35], v15 offset:0
    ds_read_b128 v[36:39], v15 offset:4096
    ds_read_b64_tr_b16 v[40:41], v8 offset:6144
    ds_read_b64_tr_b16 v[42:43], v8 offset:6656
    ds_read_b64_tr_b16 v[44:45], v8 offset:14336
    ds_read_b64_tr_b16 v[46:47], v8 offset:14848
    s_waitcnt lgkmcnt(6)
    v_mfma_f32_32x32x16_bf16 v[64:79], v[24:27], v[16:19], v[64:79]
    v_mfma_f32_32x32x16_bf16 v[80:95], v[28:31], v[16:19], v[80:95]
    v_mfma_f32_32x32x16_bf16 v[96:111], v[24:27], v[20:23], v[96:111]
    v_mfma_f32_32x32x16_bf16 v[112:127], v[28:31], v[20:23], v[112:127]
    s_waitcnt lgkmcnt(0)
    v_mfma_f32_32x32x16_bf16 v[64:79], v[40:43], v[32:35], v[64:79]
    v_mfma_f32_32x32x16_bf16 v[80:95], v[44:47], v[32:35], v[80:95]
    v_mfma_f32_32x32x16_bf16 v[96:111], v[40:43], v[36:39], v[96:111]
    v_mfma_f32_32x32x16_bf16 v[112:127], v[44:47], v[36:39], v[112:127]
    s_nop 7
    s_nop 7
    s_add_u32 s16, s98, 2621440
    s_addc_u32 s17, s99, 0
    s_mov_b32 s18, 6291456
    s_mov_b32 s19, 0x00020000
    s_and_b32 s26, s20, 3
    s_lshl_b32 s26, s26, 6
    v_and_b32 v1, 31, v0
    v_add_u32 v1, s26, v1
    v_lshlrev_b32 v2, 7, v1
    s_lshr_b32 s26, s20, 2
    s_lshl_b32 s26, s26, 2
    v_lshrrev_b32 v1, 5, v0
    v_add_u32 v1, s26, v1
    v_and_b32 v3, 7, v0
    v_xor_b32 v1, v1, v3
    v_lshl_add_u32 v2, v1, 4, v2
    v_xor_b32 v3, 32, v2
    s_lshl_b32 s26, s20, 5
    s_add_u32 s26, s26, s21
    v_lshrrev_b32 v1, 3, v0
    v_add_u32 v4, s26, v1
    v_mul_u32_u24 v4, 3072, v4
    v_xor_b32 v1, v1, v0
    v_and_b32 v1, 7, v1
    v_lshl_add_u32 v4, v1, 4, v4
    v_add_u32 v4, s22, v4
    s_lshl_b32 s26, s20, 12
    v_lshlrev_b32 v5, 4, v0
    v_add_u32 v5, s26, v5
    s_barrier
    v_max_f32 v64, 0, v64
    v_max_f32 v65, 0, v65
    v_max_f32 v66, 0, v66
    v_max_f32 v67, 0, v67
    v_max_f32 v68, 0, v68
    v_max_f32 v69, 0, v69
    v_max_f32 v70, 0, v70
    v_max_f32 v71, 0, v71
    v_mul_f32 v64, v64, v80
    v_mul_f32 v65, v65, v81
    v_mul_f32 v66, v66, v82
    v_mul_f32 v67, v67, v83
    v_mul_f32 v68, v68, v84
    v_mul_f32 v69, v69, v85
    v_mul_f32 v70, v70, v86
    v_mul_f32 v71, v71, v87
    v_cvt_pk_bf16_f32 v16, v64, v65
    v_cvt_pk_bf16_f32 v17, v66, v67
    v_cvt_pk_bf16_f32 v18, v68, v69
    v_cvt_pk_bf16_f32 v19, v70, v71
    ds_write_b128 v2, v[16:19] offset:0
    v_max_f32 v72, 0, v72
    v_max_f32 v73, 0, v73
    v_max_f32 v74, 0, v74
    v_max_f32 v75, 0, v75
    v_max_f32 v76, 0, v76
    v_max_f32 v77, 0, v77
    v_max_f32 v78, 0, v78
    v_max_f32 v79, 0, v79
    v_mul_f32 v72, v72, v88
    v_mul_f32 v73, v73, v89
    v_mul_f32 v74, v74, v90
    v_mul_f32 v75, v75, v91
    v_mul_f32 v76, v76, v92
    v_mul_f32 v77, v77, v93
    v_mul_f32 v78, v78, v94
    v_mul_f32 v79, v79, v95
    v_cvt_pk_bf16_f32 v20, v72, v73
    v_cvt_pk_bf16_f32 v21, v74, v75
    v_cvt_pk_bf16_f32 v22, v76, v77
    v_cvt_pk_bf16_f32 v23, v78, v79
    ds_write_b128 v3, v[20:23] offset:0
    v_max_f32 v96, 0, v96
    v_max_f32 v97, 0, v97
    v_max_f32 v98, 0, v98
    v_max_f32 v99, 0, v99
    v_max_f32 v100, 0, v100
    v_max_f32 v101, 0, v101
    v_max_f32 v102, 0, v102
    v_max_f32 v103, 0, v103
    v_mul_f32 v96, v96, v112
    v_mul_f32 v97, v97, v113
    v_mul_f32 v98, v98, v114
    v_mul_f32 v99, v99, v115
    v_mul_f32 v100, v100, v116
    v_mul_f32 v101, v101, v117
    v_mul_f32 v102, v102, v118
    v_mul_f32 v103, v103, v119
    v_cvt_pk_bf16_f32 v24, v96, v97
    v_cvt_pk_bf16_f32 v25, v98, v99
    v_cvt_pk_bf16_f32 v26, v100, v101
    v_cvt_pk_bf16_f32 v27, v102, v103
    ds_write_b128 v2, v[24:27] offset:4096
    v_max_f32 v104, 0, v104
    v_max_f32 v105, 0, v105
    v_max_f32 v106, 0, v106
    v_max_f32 v107, 0, v107
    v_max_f32 v108, 0, v108
    v_max_f32 v109, 0, v109
    v_max_f32 v110, 0, v110
    v_max_f32 v111, 0, v111
    v_mul_f32 v104, v104, v120
    v_mul_f32 v105, v105, v121
    v_mul_f32 v106, v106, v122
    v_mul_f32 v107, v107, v123
    v_mul_f32 v108, v108, v124
    v_mul_f32 v109, v109, v125
    v_mul_f32 v110, v110, v126
    v_mul_f32 v111, v111, v127
    v_cvt_pk_bf16_f32 v28, v104, v105
    v_cvt_pk_bf16_f32 v29, v106, v107
    v_cvt_pk_bf16_f32 v30, v108, v109
    v_cvt_pk_bf16_f32 v31, v110, v111
    ds_write_b128 v3, v[28:31] offset:4096
    s_waitcnt lgkmcnt(0)
    s_barrier
    ds_read_b128 v[64:67], v5 offset:0
    ds_read_b128 v[68:71], v5 offset:1024
    ds_read_b128 v[72:75], v5 offset:2048
    ds_read_b128 v[76:79], v5 offset:3072
    s_waitcnt lgkmcnt(3)
    s_mov_b32 s26, 0
    buffer_store_dwordx4 v[64:67], v4, s[16:19], s26 offen offset:0 sc1
    s_waitcnt lgkmcnt(2)
    s_mov_b32 s26, 24576
    buffer_store_dwordx4 v[68:71], v4, s[16:19], s26 offen offset:0 sc1
    s_waitcnt lgkmcnt(1)
    s_mov_b32 s26, 49152
    buffer_store_dwordx4 v[72:75], v4, s[16:19], s26 offen offset:0 sc1
    s_waitcnt lgkmcnt(0)
    s_mov_b32 s26, 73728
    buffer_store_dwordx4 v[76:79], v4, s[16:19], s26 offen offset:0 sc1
    s_endpgm
Lp_q:
    s_sub_u32 s3, s2, 192
    s_bfe_u32 s26, s3, 0x20001
    s_mul_i32 s26, s26, 5
    s_lshr_b32 s27, s3, 3
    s_add_u32 s27, s26, s27
    s_and_b32 s35, s27, 3
    s_and_b32 s26, s3, 1
    s_lshl_b32 s26, s26, 2
    s_add_u32 s26, s26, s35
    s_lshl_b32 s21, s26, 8
    s_mul_i32 s35, s35, 3
    s_lshr_b32 s26, s27, 2
    s_lshl_b32 s22, s26, 8
    s_add_u32 s23, s22, 128
    s_mov_b32 s24, 0
    s_add_u32 s26, s26, 6
    s_mul_i32 s26, s26, 7
    s_add_u32 s35, s35, s26
    s_mul_i32 s26, s35, 6554
    s_lshr_b32 s26, s26, 16
    s_mul_i32 s26, s26, 10
    s_sub_u32 s35, s35, s26
    s_cmp_ge_u32 s20, 4
    s_cselect_b32 s25, s23, s22
    s_lshl_b32 s26, s20, 5
    s_add_u32 s26, s26, s21
    v_lshrrev_b32 v1, 3, v0
    v_add_u32 v1, s26, v1
    s_mov_b32 s27, 1280
    v_mul_lo_u32 v2, v1, s27
    s_lshl_b32 s26, s24, 1
    v_add_u32 v2, s26, v2
    v_lshrrev_b32 v1, 4, v0
    v_xor_b32 v1, v1, v0
    v_and_b32 v1, 7, v1
    v_xor_b32 v9, 4, v1
    v_add_u32 v3, 10240, v2
    v_lshl_add_u32 v2, v1, 4, v2
    v_lshl_add_u32 v3, v9, 4, v3
    v_add_u32 v4, 20480, v2
    v_add_u32 v5, 20480, v3
    s_and_b32 s26, s20, 3
    s_mul_i32 s26, s26, 16
    s_add_u32 s26, s26, s24
    v_lshrrev_b32 v1, 3, v0
    v_add_u32 v1, s26, v1
    s_mov_b32 s27, 1280
    v_mul_lo_u32 v10, v1, s27
    v_lshrrev_b32 v1, 2, v0
    v_and_b32 v1, 4, v1
    v_xor_b32 v1, v1, v0
    v_and_b32 v1, 7, v1
    v_lshl_add_u32 v10, v1, 4, v10
    v_add_u32 v10, s25, v10
    v_add_u32 v11, 10240, v10
    s_lshl_b32 s28, s20, 12
    s_mul_i32 s38, s20, 2048
    s_lshl_b32 s29, s35, 7
    s_mul_i32 s30, s35, 81920
    s_waitcnt lgkmcnt(0)
    s_mov_b32 s4, s64
    s_mov_b32 s5, s65
    s_mov_b32 s6, 2621440
    s_mov_b32 s7, 0x00020000
    s_mov_b32 s8, s66
    s_mov_b32 s9, s67
    s_mov_b32 s10, 819200
    s_mov_b32 s11, 0x00020000
    s_mov_b32 s12, s66
    s_mov_b32 s13, s67
    s_mov_b32 s14, 819200
    s_mov_b32 s15, 0x00020000
    s_cmp_ge_u32 s20, 4
    s_cselect_b32 s8, s12, s8
    s_cselect_b32 s9, s13, s9
    s_cselect_b32 s10, s14, s10
    s_add_u32 m0, s28, 0
    s_nop 0
    buffer_load_dwordx4 v2, s[4:7], s29 offen lds
    s_add_u32 m0, s28, 1024
    s_nop 0
    buffer_load_dwordx4 v3, s[4:7], s29 offen lds
    s_add_u32 m0, s28, 2048
    s_nop 0
    buffer_load_dwordx4 v4, s[4:7], s29 offen lds
    s_add_u32 m0, s28, 3072
    s_nop 0
    buffer_load_dwordx4 v5, s[4:7], s29 offen lds
    s_add_u32 s29, s29, 128
    s_cmp_eq_u32 s29, 1280
    s_cselect_b32 s29, 0, s29
    s_add_u32 m0, s38, 98304
    s_nop 0
    buffer_load_dwordx4 v10, s[8:11], s30 offen lds
    s_add_u32 m0, s38, 99328
    s_nop 0
    buffer_load_dwordx4 v11, s[8:11], s30 offen lds
    s_add_u32 s30, s30, 81920
    s_cmp_eq_u32 s30, 819200
    s_cselect_b32 s30, 0, s30
    s_add_u32 m0, s28, 32768
    s_nop 0
    buffer_load_dwordx4 v2, s[4:7], s29 offen lds
    s_add_u32 m0, s28, 33792
    s_nop 0
    buffer_load_dwordx4 v3, s[4:7], s29 offen lds
    s_add_u32 m0, s28, 34816
    s_nop 0
    buffer_load_dwordx4 v4, s[4:7], s29 offen lds
    s_add_u32 m0, s28, 35840
    s_nop 0
    buffer_load_dwordx4 v5, s[4:7], s29 offen lds
    s_add_u32 s29, s29, 128
    s_cmp_eq_u32 s29, 1280
    s_cselect_b32 s29, 0, s29
    s_add_u32 m0, s38, 114688
    s_nop 0
    buffer_load_dwordx4 v10, s[8:11], s30 offen lds
    s_add_u32 m0, s38, 115712
    s_nop 0
    buffer_load_dwordx4 v11, s[8:11], s30 offen lds
    s_add_u32 s30, s30, 81920
    s_cmp_eq_u32 s30, 819200
    s_cselect_b32 s30, 0, s30
    s_and_b32 s26, s20, 3
    s_lshl_b32 s26, s26, 6
    v_and_b32 v1, 31, v0
    v_add_u32 v1, s26, v1
    v_lshlrev_b32 v6, 7, v1
    v_lshrrev_b32 v1, 5, v0
    v_bfe_u32 v9, v0, 1, 3
    v_xor_b32 v1, v1, v9
    v_lshl_add_u32 v6, v1, 4, v6
    v_xor_b32 v7, 32, v6
    v_xor_b32 v14, 64, v6
    v_xor_b32 v15, 96, v6
    v_add_u32 v48, 65536, v6
    v_add_u32 v49, 65536, v7
    v_add_u32 v50, 65536, v14
    v_add_u32 v51, 65536, v15
    v_lshrrev_b32 v1, 5, v0
    v_lshlrev_b32 v1, 3, v1
    v_bfe_u32 v9, v0, 2, 2
    v_add_u32 v1, v1, v9
    v_lshlrev_b32 v8, 7, v1
    v_and_b32 v1, 1, v0
    v_lshlrev_b32 v1, 1, v1
    v_bfe_u32 v9, v0, 1, 1
    v_or_b32 v1, v1, v9
    v_lshlrev_b32 v1, 3, v1
    v_bfe_u32 v9, v0, 4, 1
    v_lshl_add_u32 v1, v9, 5, v1
    s_lshr_b32 s26, s20, 2
    s_lshl_b32 s26, s26, 6
    v_add_u32 v1, s26, v1
    v_bfe_u32 v9, v0, 3, 1
    v_lshlrev_b32 v9, 6, v9
    v_xor_b32 v1, v1, v9
    v_add_u32 v8, v8, v1
    v_add_u32 v8, 98304, v8
    v_mov_b32 v64, 0
    v_mov_b32 v65, 0
    v_mov_b32 v66, 0
    v_mov_b32 v67, 0
    v_mov_b32 v68, 0
    v_mov_b32 v69, 0
    v_mov_b32 v70, 0
    v_mov_b32 v71, 0
    v_mov_b32 v72, 0
    v_mov_b32 v73, 0
    v_mov_b32 v74, 0
    v_mov_b32 v75, 0
    v_mov_b32 v76, 0
    v_mov_b32 v77, 0
    v_mov_b32 v78, 0
    v_mov_b32 v79, 0
    v_mov_b32 v80, 0
    v_mov_b32 v81, 0
    v_mov_b32 v82, 0
    v_mov_b32 v83, 0
    v_mov_b32 v84, 0
    v_mov_b32 v85, 0
    v_mov_b32 v86, 0
    v_mov_b32 v87, 0
    v_mov_b32 v88, 0
    v_mov_b32 v89, 0
    v_mov_b32 v90, 0
    v_mov_b32 v91, 0
    v_mov_b32 v92, 0
    v_mov_b32 v93, 0
    v_mov_b32 v94, 0
    v_mov_b32 v95, 0
    v_mov_b32 v96, 0
    v_mov_b32 v97, 0
    v_mov_b32 v98, 0
    v_mov_b32 v99, 0
    v_mov_b32 v100, 0
    v_mov_b32 v101, 0
    v_mov_b32 v102, 0
    v_mov_b32 v103, 0
    v_mov_b32 v104, 0
    v_mov_b32 v105, 0
    v_mov_b32 v106, 0
    v_mov_b32 v107, 0
    v_mov_b32 v108, 0
    v_mov_b32 v109, 0
    v_mov_b32 v110, 0
    v_mov_b32 v111, 0
    v_mov_b32 v112, 0
    v_mov_b32 v113, 0
    v_mov_b32 v114, 0
    v_mov_b32 v115, 0
    v_mov_b32 v116, 0
    v_mov_b32 v117, 0
    v_mov_b32 v118, 0
    v_mov_b32 v119, 0
    v_mov_b32 v120, 0
    v_mov_b32 v121, 0
    v_mov_b32 v122, 0
    v_mov_b32 v123, 0
    v_mov_b32 v124, 0
    v_mov_b32 v125, 0
    v_mov_b32 v126, 0
    v_mov_b32 v127, 0
    s_waitcnt vmcnt(6)
    s_barrier
    ds_read_b128 v[16:19], v6 offset:0
    ds_read_b128 v[20:23], v6 offset:4096
    ds_read_b64_tr_b16 v[24:25], v8 offset:0
    ds_read_b64_tr_b16 v[26:27], v8 offset:512
    ds_read_b64_tr_b16 v[28:29], v8 offset:8192
    ds_read_b64_tr_b16 v[30:31], v8 offset:8704
    ds_read_b128 v[32:35], v7 offset:0
    ds_read_b128 v[36:39], v7 offset:4096
    ds_read_b64_tr_b16 v[40:41], v8 offset:2048
    ds_read_b64_tr_b16 v[42:43], v8 offset:2560
    ds_read_b64_tr_b16 v[44:45], v8 offset:10240
    ds_read_b64_tr_b16 v[46:47], v8 offset:10752
    s_waitcnt vmcnt(0)
    s_barrier
    s_waitcnt lgkmcnt(6)
    v_mfma_f32_32x32x16_bf16 v[64:79], v[24:27], v[16:19], v[64:79]
    s_add_u32 m0, s38, 131072
    s_nop 0
    buffer_load_dwordx4 v10, s[8:11], s30 offen lds
    v_mfma_f32_32x32x16_bf16 v[80:95], v[28:31], v[16:19], v[80:95]
    v_mfma_f32_32x32x16_bf16 v[96:111], v[24:27], v[20:23], v[96:111]
    s_add_u32 m0, s38, 132096
    s_nop 0
    buffer_load_dwordx4 v11, s[8:11], s30 offen lds
    s_add_u32 s30, s30, 81920
    s_cmp_eq_u32 s30, 819200
    s_cselect_b32 s30, 0, s30
    v_mfma_f32_32x32x16_bf16 v[112:127], v[28:31], v[20:23], v[112:127]
    ds_read_b128 v[16:19], v14 offset:0
    ds_read_b128 v[20:23], v14 offset:4096
    ds_read_b64_tr_b16 v[24:25], v8 offset:4096
    ds_read_b64_tr_b16 v[26:27], v8 offset:4608
    ds_read_b64_tr_b16 v[28:29], v8 offset:12288
    ds_read_b64_tr_b16 v[30:31], v8 offset:12800
    s_waitcnt lgkmcnt(6)
    v_mfma_f32_32x32x16_bf16 v[64:79], v[40:43], v[32:35], v[64:79]
    s_add_u32 m0, s28, 65536
    s_nop 0
    buffer_load_dwordx4 v2, s[4:7], s29 offen lds
    v_mfma_f32_32x32x16_bf16 v[80:95], v[44:47], v[32:35], v[80:95]
    v_mfma_f32_32x32x16_bf16 v[96:111], v[40:43], v[36:39], v[96:111]
    s_add_u32 m0, s28, 66560
    s_nop 0
    buffer_load_dwordx4 v3, s[4:7], s29 offen lds
    v_mfma_f32_32x32x16_bf16 v[112:127], v[44:47], v[36:39], v[112:127]
    ds_read_b128 v[32:35], v15 offset:0
    ds_read_b128 v[36:39], v15 offset:4096
    ds_read_b64_tr_b16 v[40:41], v8 offset:6144
    ds_read_b64_tr_b16 v[42:43], v8 offset:6656
    ds_read_b64_tr_b16 v[44:45], v8 offset:14336
    ds_read_b64_tr_b16 v[46:47], v8 offset:14848
    s_waitcnt lgkmcnt(6)
    v_mfma_f32_32x32x16_bf16 v[64:79], v[24:27], v[16:19], v[64:79]
    s_add_u32 m0, s28, 67584
    s_nop 0
    buffer_load_dwordx4 v4, s[4:7], s29 offen lds
    v_mfma_f32_32x32x16_bf16 v[80:95], v[28:31], v[16:19], v[80:95]
    v_mfma_f32_32x32x16_bf16 v[96:111], v[24:27], v[20:23], v[96:111]
    s_add_u32 m0, s28, 68608
    s_nop 0
    buffer_load_dwordx4 v5, s[4:7], s29 offen lds
    s_add_u32 s29, s29, 128
    s_cmp_eq_u32 s29, 1280
    s_cselect_b32 s29, 0, s29
    v_mfma_f32_32x32x16_bf16 v[112:127], v[28:31], v[20:23], v[112:127]
    ds_read_b128 v[16:19], v6 offset:32768
    ds_read_b128 v[20:23], v6 offset:36864
    ds_read_b64_tr_b16 v[24:25], v8 offset:16384
    ds_read_b64_tr_b16 v[26:27], v8 offset:16896
    ds_read_b64_tr_b16 v[28:29], v8 offset:24576
    ds_read_b64_tr_b16 v[30:31], v8 offset:25088
    s_waitcnt lgkmcnt(6)
    v_mfma_f32_32x32x16_bf16 v[64:79], v[40:43], v[32:35], v[64:79]
    v_mfma_f32_32x32x16_bf16 v[80:95], v[44:47], v[32:35], v[80:95]
    v_mfma_f32_32x32x16_bf16 v[96:111], v[40:43], v[36:39], v[96:111]
    v_mfma_f32_32x32x16_bf16 v[112:127], v[44:47], v[36:39], v[112:127]
    ds_read_b128 v[32:35], v7 offset:32768
    ds_read_b128 v[36:39], v7 offset:36864
    ds_read_b64_tr_b16 v[40:41], v8 offset:18432
    ds_read_b64_tr_b16 v[42:43], v8 offset:18944
    ds_read_b64_tr_b16 v[44:45], v8 offset:26624
    ds_read_b64_tr_b16 v[46:47], v8 offset:27136
    s_waitcnt vmcnt(0)
    s_barrier
    s_waitcnt lgkmcnt(6)
    v_mfma_f32_32x32x16_bf16 v[64:79], v[24:27], v[16:19], v[64:79]
    s_add_u32 m0, s38, 98304
    s_nop 0
    buffer_load_dwordx4 v10, s[8:11], s30 offen lds
    v_mfma_f32_32x32x16_bf16 v[80:95], v[28:31], v[16:19], v[80:95]
    v_mfma_f32_32x32x16_bf16 v[96:111], v[24:27], v[20:23], v[96:111]
    s_add_u32 m0, s38, 99328
    s_nop 0
    buffer_load_dwordx4 v11, s[8:11], s30 offen lds
    s_add_u32 s30, s30, 81920
    s_cmp_eq_u32 s30, 819200
    s_cselect_b32 s30, 0, s30
    v_mfma_f32_32x32x16_bf16 v[112:127], v[28:31], v[20:23], v[112:127]
    ds_read_b128 v[16:19], v14 offset:32768
    ds_read_b128 v[20:23], v14 offset:36864
    ds_read_b64_tr_b16 v[24:25], v8 offset:20480
    ds_read_b64_tr_b16 v[26:27], v8 offset:20992
    ds_read_b64_tr_b16 v[28:29], v8 offset:28672
    ds_read_b64_tr_b16 v[30:31], v8 offset:29184
    s_waitcnt lgkmcnt(6)
    v_mfma_f32_32x32x16_bf16 v[64:79], v[40:43], v[32:35], v[64:79]
    s_add_u32 m0, s28, 0
    s_nop 0
    buffer_load_dwordx4 v2, s[4:7], s29 offen lds
    v_mfma_f32_32x32x16_bf16 v[80:95], v[44:47], v[32:35], v[80:95]
    v_mfma_f32_32x32x16_bf16 v[96:111], v[40:43], v[36:39], v[96:111]
    s_add_u32 m0, s28, 1024
    s_nop 0
    buffer_load_dwordx4 v3, s[4:7], s29 offen lds
    v_mfma_f32_32x32x16_bf16 v[112:127], v[44:47], v[36:39], v[112:127]
    ds_read_b128 v[32:35], v15 offset:32768
    ds_read_b128 v[36:39], v15 offset:36864
    ds_read_b64_tr_b16 v[40:41], v8 offset:22528
    ds_read_b64_tr_b16 v[42:43], v8 offset:23040
    ds_read_b64_tr_b16 v[44:45], v8 offset:30720
    ds_read_b64_tr_b16 v[46:47], v8 offset:31232
    s_waitcnt lgkmcnt(6)
    v_mfma_f32_32x32x16_bf16 v[64:79], v[24:27], v[16:19], v[64:79]
    s_add_u32 m0, s28, 2048
    s_nop 0
    buffer_load_dwordx4 v4, s[4:7], s29 offen lds
    v_mfma_f32_32x32x16_bf16 v[80:95], v[28:31], v[16:19], v[80:95]
    v_mfma_f32_32x32x16_bf16 v[96:111], v[24:27], v[20:23], v[96:111]
    s_add_u32 m0, s28, 3072
    s_nop 0
    buffer_load_dwordx4 v5, s[4:7], s29 offen lds
    s_add_u32 s29, s29, 128
    s_cmp_eq_u32 s29, 1280
    s_cselect_b32 s29, 0, s29
    v_mfma_f32_32x32x16_bf16 v[112:127], v[28:31], v[20:23], v[112:127]
    ds_read_b128 v[16:19], v48 offset:0
    ds_read_b128 v[20:23], v48 offset:4096
    ds_read_b64_tr_b16 v[24:25], v8 offset:32768
    ds_read_b64_tr_b16 v[26:27], v8 offset:33280
    ds_read_b64_tr_b16 v[28:29], v8 offset:40960
    ds_read_b64_tr_b16 v[30:31], v8 offset:41472
    s_waitcnt lgkmcnt(6)
    v_mfma_f32_32x32x16_bf16 v[64:79], v[40:43], v[32:35], v[64:79]
    v_mfma_f32_32x32x16_bf16 v[80:95], v[44:47], v[32:35], v[80:95]
    v_mfma_f32_32x32x16_bf16 v[96:111], v[40:43], v[36:39], v[96:111]
    v_mfma_f32_32x32x16_bf16 v[112:127], v[44:47], v[36:39], v[112:127]
    ds_read_b128 v[32:35], v49 offset:0
    ds_read_b128 v[36:39], v49 offset:4096
    ds_read_b64_tr_b16 v[40:41], v8 offset:34816
    ds_read_b64_tr_b16 v[42:43], v8 offset:35328
    ds_read_b64_tr_b16 v[44:45], v8 offset:43008
    ds_read_b64_tr_b16 v[46:47], v8 offset:43520
    s_waitcnt vmcnt(0)
    s_barrier
    s_waitcnt lgkmcnt(6)
    v_mfma_f32_32x32x16_bf16 v[64:79], v[24:27], v[16:19], v[64:79]
    s_add_u32 m0, s38, 114688
    s_nop 0
    buffer_load_dwordx4 v10, s[8:11], s30 offen lds
    v_mfma_f32_32x32x16_bf16 v[80:95], v[28:31], v[16:19], v[80:95]
    v_mfma_f32_32x32x16_bf16 v[96:111], v[24:27], v[20:23], v[96:111]
    s_add_u32 m0, s38, 115712
    s_nop 0
    buffer_load_dwordx4 v11, s[8:11], s30 offen lds
    s_add_u32 s30, s30, 81920
    s_cmp_eq_u32 s30, 819200
    s_cselect_b32 s30, 0, s30
    v_mfma_f32_32x32x16_bf16 v[112:127], v[28:31], v[20:23], v[112:127]
    ds_read_b128 v[16:19], v50 offset:0
    ds_read_b128 v[20:23], v50 offset:4096
    ds_read_b64_tr_b16 v[24:25], v8 offset:36864
    ds_read_b64_tr_b16 v[26:27], v8 offset:37376
    ds_read_b64_tr_b16 v[28:29], v8 offset:45056
    ds_read_b64_tr_b16 v[30:31], v8 offset:45568
    s_waitcnt lgkmcnt(6)
    v_mfma_f32_32x32x16_bf16 v[64:79], v[40:43], v[32:35], v[64:79]
    s_add_u32 m0, s28, 32768
    s_nop 0
    buffer_load_dwordx4 v2, s[4:7], s29 offen lds
    v_mfma_f32_32x32x16_bf16 v[80:95], v[44:47], v[32:35], v[80:95]
    v_mfma_f32_32x32x16_bf16 v[96:111], v[40:43], v[36:39], v[96:111]
    s_add_u32 m0, s28, 33792
    s_nop 0
    buffer_load_dwordx4 v3, s[4:7], s29 offen lds
    v_mfma_f32_32x32x16_bf16 v[112:127], v[44:47], v[36:39], v[112:127]
    ds_read_b128 v[32:35], v51 offset:0
    ds_read_b128 v[36:39], v51 offset:4096
    ds_read_b64_tr_b16 v[40:41], v8 offset:38912
    ds_read_b64_tr_b16 v[42:43], v8 offset:39424
    ds_read_b64_tr_b16 v[44:45], v8 offset:47104
    ds_read_b64_tr_b16 v[46:47], v8 offset:47616
    s_waitcnt lgkmcnt(6)
    v_mfma_f32_32x32x16_bf16 v[64:79], v[24:27], v[16:19], v[64:79]
    s_add_u32 m0, s28, 34816
    s_nop 0
    buffer_load_dwordx4 v4, s[4:7], s29 offen lds
    v_mfma_f32_32x32x16_bf16 v[80:95], v[28:31], v[16:19], v[80:95]
    v_mfma_f32_32x32x16_bf16 v[96:111], v[24:27], v[20:23], v[96:111]
    s_add_u32 m0, s28, 35840
    s_nop 0
    buffer_load_dwordx4 v5, s[4:7], s29 offen lds
    s_add_u32 s29, s29, 128
    s_cmp_eq_u32 s29, 1280
    s_cselect_b32 s29, 0, s29
    v_mfma_f32_32x32x16_bf16 v[112:127], v[28:31], v[20:23], v[112:127]
    ds_read_b128 v[16:19], v6 offset:0
    ds_read_b128 v[20:23], v6 offset:4096
    ds_read_b64_tr_b16 v[24:25], v8 offset:0
    ds_read_b64_tr_b16 v[26:27], v8 offset:512
    ds_read_b64_tr_b16 v[28:29], v8 offset:8192
    ds_read_b64_tr_b16 v[30:31], v8 offset:8704
    s_waitcnt lgkmcnt(6)
    v_mfma_f32_32x32x16_bf16 v[64:79], v[40:43], v[32:35], v[64:79]
    v_mfma_f32_32x32x16_bf16 v[80:95], v[44:47], v[32:35], v[80:95]
    v_mfma_f32_32x32x16_bf16 v[96:111], v[40:43], v[36:39], v[96:111]
    v_mfma_f32_32x32x16_bf16 v[112:127], v[44:47], v[36:39], v[112:127]
    ds_read_b128 v[32:35], v7 offset:0
    ds_read_b128 v[36:39], v7 offset:4096
    ds_read_b64_tr_b16 v[40:41], v8 offset:2048
    ds_read_b64_tr_b16 v[42:43], v8 offset:2560
    ds_read_b64_tr_b16 v[44:45], v8 offset:10240
    ds_read_b64_tr_b16 v[46:47], v8 offset:10752
    s_waitcnt vmcnt(0)
    s_barrier
    s_waitcnt lgkmcnt(6)
    v_mfma_f32_32x32x16_bf16 v[64:79], v[24:27], v[16:19], v[64:79]
    s_add_u32 m0, s38, 131072
    s_nop 0
    buffer_load_dwordx4 v10, s[8:11], s30 offen lds
    v_mfma_f32_32x32x16_bf16 v[80:95], v[28:31], v[16:19], v[80:95]
    v_mfma_f32_32x32x16_bf16 v[96:111], v[24:27], v[20:23], v[96:111]
    s_add_u32 m0, s38, 132096
    s_nop 0
    buffer_load_dwordx4 v11, s[8:11], s30 offen lds
    s_add_u32 s30, s30, 81920
    s_cmp_eq_u32 s30, 819200
    s_cselect_b32 s30, 0, s30
    v_mfma_f32_32x32x16_bf16 v[112:127], v[28:31], v[20:23], v[112:127]
    ds_read_b128 v[16:19], v14 offset:0
    ds_read_b128 v[20:23], v14 offset:4096
    ds_read_b64_tr_b16 v[24:25], v8 offset:4096
    ds_read_b64_tr_b16 v[26:27], v8 offset:4608
    ds_read_b64_tr_b16 v[28:29], v8 offset:12288
    ds_read_b64_tr_b16 v[30:31], v8 offset:12800
    s_waitcnt lgkmcnt(6)
    v_mfma_f32_32x32x16_bf16 v[64:79], v[40:43], v[32:35], v[64:79]
    s_add_u32 m0, s28, 65536
    s_nop 0
    buffer_load_dwordx4 v2, s[4:7], s29 offen lds
    v_mfma_f32_32x32x16_bf16 v[80:95], v[44:47], v[32:35], v[80:95]
    v_mfma_f32_32x32x16_bf16 v[96:111], v[40:43], v[36:39], v[96:111]
    s_add_u32 m0, s28, 66560
    s_nop 0
    buffer_load_dwordx4 v3, s[4:7], s29 offen lds
    v_mfma_f32_32x32x16_bf16 v[112:127], v[44:47], v[36:39], v[112:127]
    ds_read_b128 v[32:35], v15 offset:0
    ds_read_b128 v[36:39], v15 offset:4096
    ds_read_b64_tr_b16 v[40:41], v8 offset:6144
    ds_read_b64_tr_b16 v[42:43], v8 offset:6656
    ds_read_b64_tr_b16 v[44:45], v8 offset:14336
    ds_read_b64_tr_b16 v[46:47], v8 offset:14848
    s_waitcnt lgkmcnt(6)
    v_mfma_f32_32x32x16_bf16 v[64:79], v[24:27], v[16:19], v[64:79]
    s_add_u32 m0, s28, 67584
    s_nop 0
    buffer_load_dwordx4 v4, s[4:7], s29 offen lds
    v_mfma_f32_32x32x16_bf16 v[80:95], v[28:31], v[16:19], v[80:95]
    v_mfma_f32_32x32x16_bf16 v[96:111], v[24:27], v[20:23], v[96:111]
    s_add_u32 m0, s28, 68608
    s_nop 0
    buffer_load_dwordx4 v5, s[4:7], s29 offen lds
    s_add_u32 s29, s29, 128
    s_cmp_eq_u32 s29, 1280
    s_cselect_b32 s29, 0, s29
    v_mfma_f32_32x32x16_bf16 v[112:127], v[28:31], v[20:23], v[112:127]
    ds_read_b128 v[16:19], v6 offset:32768
    ds_read_b128 v[20:23], v6 offset:36864
    ds_read_b64_tr_b16 v[24:25], v8 offset:16384
    ds_read_b64_tr_b16 v[26:27], v8 offset:16896
    ds_read_b64_tr_b16 v[28:29], v8 offset:24576
    ds_read_b64_tr_b16 v[30:31], v8 offset:25088
    s_waitcnt lgkmcnt(6)
    v_mfma_f32_32x32x16_bf16 v[64:79], v[40:43], v[32:35], v[64:79]
    v_mfma_f32_32x32x16_bf16 v[80:95], v[44:47], v[32:35], v[80:95]
    v_mfma_f32_32x32x16_bf16 v[96:111], v[40:43], v[36:39], v[96:111]
    v_mfma_f32_32x32x16_bf16 v[112:127], v[44:47], v[36:39], v[112:127]
    ds_read_b128 v[32:35], v7 offset:32768
    ds_read_b128 v[36:39], v7 offset:36864
    ds_read_b64_tr_b16 v[40:41], v8 offset:18432
    ds_read_b64_tr_b16 v[42:43], v8 offset:18944
    ds_read_b64_tr_b16 v[44:45], v8 offset:26624
    ds_read_b64_tr_b16 v[46:47], v8 offset:27136
    s_waitcnt vmcnt(0)
    s_barrier
    s_waitcnt lgkmcnt(6)
    v_mfma_f32_32x32x16_bf16 v[64:79], v[24:27], v[16:19], v[64:79]
    s_add_u32 m0, s38, 98304
    s_nop 0
    buffer_load_dwordx4 v10, s[8:11], s30 offen lds
    v_mfma_f32_32x32x16_bf16 v[80:95], v[28:31], v[16:19], v[80:95]
    v_mfma_f32_32x32x16_bf16 v[96:111], v[24:27], v[20:23], v[96:111]
    s_add_u32 m0, s38, 99328
    s_nop 0
    buffer_load_dwordx4 v11, s[8:11], s30 offen lds
    s_add_u32 s30, s30, 81920
    s_cmp_eq_u32 s30, 819200
    s_cselect_b32 s30, 0, s30
    v_mfma_f32_32x32x16_bf16 v[112:127], v[28:31], v[20:23], v[112:127]
    ds_read_b128 v[16:19], v14 offset:32768
    ds_read_b128 v[20:23], v14 offset:36864
    ds_read_b64_tr_b16 v[24:25], v8 offset:20480
    ds_read_b64_tr_b16 v[26:27], v8 offset:20992
    ds_read_b64_tr_b16 v[28:29], v8 offset:28672
    ds_read_b64_tr_b16 v[30:31], v8 offset:29184
    s_waitcnt lgkmcnt(6)
    v_mfma_f32_32x32x16_bf16 v[64:79], v[40:43], v[32:35], v[64:79]
    s_add_u32 m0, s28, 0
    s_nop 0
    buffer_load_dwordx4 v2, s[4:7], s29 offen lds
    v_mfma_f32_32x32x16_bf16 v[80:95], v[44:47], v[32:35], v[80:95]
    v_mfma_f32_32x32x16_bf16 v[96:111], v[40:43], v[36:39], v[96:111]
    s_add_u32 m0, s28, 1024
    s_nop 0
    buffer_load_dwordx4 v3, s[4:7], s29 offen lds
    v_mfma_f32_32x32x16_bf16 v[112:127], v[44:47], v[36:39], v[112:127]
    ds_read_b128 v[32:35], v15 offset:32768
    ds_read_b128 v[36:39], v15 offset:36864
    ds_read_b64_tr_b16 v[40:41], v8 offset:22528
    ds_read_b64_tr_b16 v[42:43], v8 offset:23040
    ds_read_b64_tr_b16 v[44:45], v8 offset:30720
    ds_read_b64_tr_b16 v[46:47], v8 offset:31232
    s_waitcnt lgkmcnt(6)
    v_mfma_f32_32x32x16_bf16 v[64:79], v[24:27], v[16:19], v[64:79]
    s_add_u32 m0, s28, 2048
    s_nop 0
    buffer_load_dwordx4 v4, s[4:7], s29 offen lds
    v_mfma_f32_32x32x16_bf16 v[80:95], v[28:31], v[16:19], v[80:95]
    v_mfma_f32_32x32x16_bf16 v[96:111], v[24:27], v[20:23], v[96:111]
    s_add_u32 m0, s28, 3072
    s_nop 0
    buffer_load_dwordx4 v5, s[4:7], s29 offen lds
    s_add_u32 s29, s29, 128
    s_cmp_eq_u32 s29, 1280
    s_cselect_b32 s29, 0, s29
    v_mfma_f32_32x32x16_bf16 v[112:127], v[28:31], v[20:23], v[112:127]
    ds_read_b128 v[16:19], v48 offset:0
    ds_read_b128 v[20:23], v48 offset:4096
    ds_read_b64_tr_b16 v[24:25], v8 offset:32768
    ds_read_b64_tr_b16 v[26:27], v8 offset:33280
    ds_read_b64_tr_b16 v[28:29], v8 offset:40960
    ds_read_b64_tr_b16 v[30:31], v8 offset:41472
    s_waitcnt lgkmcnt(6)
    v_mfma_f32_32x32x16_bf16 v[64:79], v[40:43], v[32:35], v[64:79]
    v_mfma_f32_32x32x16_bf16 v[80:95], v[44:47], v[32:35], v[80:95]
    v_mfma_f32_32x32x16_bf16 v[96:111], v[40:43], v[36:39], v[96:111]
    v_mfma_f32_32x32x16_bf16 v[112:127], v[44:47], v[36:39], v[112:127]
    ds_read_b128 v[32:35], v49 offset:0
    ds_read_b128 v[36:39], v49 offset:4096
    ds_read_b64_tr_b16 v[40:41], v8 offset:34816
    ds_read_b64_tr_b16 v[42:43], v8 offset:35328
    ds_read_b64_tr_b16 v[44:45], v8 offset:43008
    ds_read_b64_tr_b16 v[46:47], v8 offset:43520
    s_waitcnt vmcnt(0)
    s_barrier
    s_waitcnt lgkmcnt(6)
    v_mfma_f32_32x32x16_bf16 v[64:79], v[24:27], v[16:19], v[64:79]
    s_add_u32 m0, s38, 114688
    s_nop 0
    buffer_load_dwordx4 v10, s[8:11], s30 offen lds
    v_mfma_f32_32x32x16_bf16 v[80:95], v[28:31], v[16:19], v[80:95]
    v_mfma_f32_32x32x16_bf16 v[96:111], v[24:27], v[20:23], v[96:111]
    s_add_u32 m0, s38, 115712
    s_nop 0
    buffer_load_dwordx4 v11, s[8:11], s30 offen lds
    s_add_u32 s30, s30, 81920
    s_cmp_eq_u32 s30, 819200
    s_cselect_b32 s30, 0, s30
    v_mfma_f32_32x32x16_bf16 v[112:127], v[28:31], v[20:23], v[112:127]
    ds_read_b128 v[16:19], v50 offset:0
    ds_read_b128 v[20:23], v50 offset:4096
    ds_read_b64_tr_b16 v[24:25], v8 offset:36864
    ds_read_b64_tr_b16 v[26:27], v8 offset:37376
    ds_read_b64_tr_b16 v[28:29], v8 offset:45056
    ds_read_b64_tr_b16 v[30:31], v8 offset:45568
    s_waitcnt lgkmcnt(6)
    v_mfma_f32_32x32x16_bf16 v[64:79], v[40:43], v[32:35], v[64:79]
    s_add_u32 m0, s28, 32768
    s_nop 0
    buffer_load_dwordx4 v2, s[4:7], s29 offen lds
    v_mfma_f32_32x32x16_bf16 v[80:95], v[44:47], v[32:35], v[80:95]
    v_mfma_f32_32x32x16_bf16 v[96:111], v[40:43], v[36:39], v[96:111]
    s_add_u32 m0, s28, 33792
    s_nop 0
    buffer_load_dwordx4 v3, s[4:7], s29 offen lds
    v_mfma_f32_32x32x16_bf16 v[112:127], v[44:47], v[36:39], v[112:127]
    ds_read_b128 v[32:35], v51 offset:0
    ds_read_b128 v[36:39], v51 offset:4096
    ds_read_b64_tr_b16 v[40:41], v8 offset:38912
    ds_read_b64_tr_b16 v[42:43], v8 offset:39424
    ds_read_b64_tr_b16 v[44:45], v8 offset:47104
    ds_read_b64_tr_b16 v[46:47], v8 offset:47616
    s_waitcnt lgkmcnt(6)
    v_mfma_f32_32x32x16_bf16 v[64:79], v[24:27], v[16:19], v[64:79]
    s_add_u32 m0, s28, 34816
    s_nop 0
    buffer_load_dwordx4 v4, s[4:7], s29 offen lds
    v_mfma_f32_32x32x16_bf16 v[80:95], v[28:31], v[16:19], v[80:95]
    v_mfma_f32_32x32x16_bf16 v[96:111], v[24:27], v[20:23], v[96:111]
    s_add_u32 m0, s28, 35840
    s_nop 0
    buffer_load_dwordx4 v5, s[4:7], s29 offen lds
    s_add_u32 s29, s29, 128
    s_cmp_eq_u32 s29, 1280
    s_cselect_b32 s29, 0, s29
    v_mfma_f32_32x32x16_bf16 v[112:127], v[28:31], v[20:23], v[112:127]
    ds_read_b128 v[16:19], v6 offset:0
    ds_read_b128 v[20:23], v6 offset:4096
    ds_read_b64_tr_b16 v[24:25], v8 offset:0
    ds_read_b64_tr_b16 v[26:27], v8 offset:512
    ds_read_b64_tr_b16 v[28:29], v8 offset:8192
    ds_read_b64_tr_b16 v[30:31], v8 offset:8704
    s_waitcnt lgkmcnt(6)
    v_mfma_f32_32x32x16_bf16 v[64:79], v[40:43], v[32:35], v[64:79]
    v_mfma_f32_32x32x16_bf16 v[80:95], v[44:47], v[32:35], v[80:95]
    v_mfma_f32_32x32x16_bf16 v[96:111], v[40:43], v[36:39], v[96:111]
    v_mfma_f32_32x32x16_bf16 v[112:127], v[44:47], v[36:39], v[112:127]
    ds_read_b128 v[32:35], v7 offset:0
    ds_read_b128 v[36:39], v7 offset:4096
    ds_read_b64_tr_b16 v[40:41], v8 offset:2048
    ds_read_b64_tr_b16 v[42:43], v8 offset:2560
    ds_read_b64_tr_b16 v[44:45], v8 offset:10240
    ds_read_b64_tr_b16 v[46:47], v8 offset:10752
    s_waitcnt vmcnt(0)
    s_barrier
    s_waitcnt lgkmcnt(6)
    v_mfma_f32_32x32x16_bf16 v[64:79], v[24:27], v[16:19], v[64:79]
    s_add_u32 m0, s38, 131072
    s_nop 0
    buffer_load_dwordx4 v10, s[8:11], s30 offen lds
    v_mfma_f32_32x32x16_bf16 v[80:95], v[28:31], v[16:19], v[80:95]
    v_mfma_f32_32x32x16_bf16 v[96:111], v[24:27], v[20:23], v[96:111]
    s_add_u32 m0, s38, 132096
    s_nop 0
    buffer_load_dwordx4 v11, s[8:11], s30 offen lds
    s_add_u32 s30, s30, 81920
    s_cmp_eq_u32 s30, 819200
    s_cselect_b32 s30, 0, s30
    v_mfma_f32_32x32x16_bf16 v[112:127], v[28:31], v[20:23], v[112:127]
    ds_read_b128 v[16:19], v14 offset:0
    ds_read_b128 v[20:23], v14 offset:4096
    ds_read_b64_tr_b16 v[24:25], v8 offset:4096
    ds_read_b64_tr_b16 v[26:27], v8 offset:4608
    ds_read_b64_tr_b16 v[28:29], v8 offset:12288
    ds_read_b64_tr_b16 v[30:31], v8 offset:12800
    s_waitcnt lgkmcnt(6)
    v_mfma_f32_32x32x16_bf16 v[64:79], v[40:43], v[32:35], v[64:79]
    s_add_u32 m0, s28, 65536
    s_nop 0
    buffer_load_dwordx4 v2, s[4:7], s29 offen lds
    v_mfma_f32_32x32x16_bf16 v[80:95], v[44:47], v[32:35], v[80:95]
    v_mfma_f32_32x32x16_bf16 v[96:111], v[40:43], v[36:39], v[96:111]
    s_add_u32 m0, s28, 66560
    s_nop 0
    buffer_load_dwordx4 v3, s[4:7], s29 offen lds
    v_mfma_f32_32x32x16_bf16 v[112:127], v[44:47], v[36:39], v[112:127]
    ds_read_b128 v[32:35], v15 offset:0
    ds_read_b128 v[36:39], v15 offset:4096
    ds_read_b64_tr_b16 v[40:41], v8 offset:6144
    ds_read_b64_tr_b16 v[42:43], v8 offset:6656
    ds_read_b64_tr_b16 v[44:45], v8 offset:14336
    ds_read_b64_tr_b16 v[46:47], v8 offset:14848
    s_waitcnt lgkmcnt(6)
    v_mfma_f32_32x32x16_bf16 v[64:79], v[24:27], v[16:19], v[64:79]
    s_add_u32 m0, s28, 67584
    s_nop 0
    buffer_load_dwordx4 v4, s[4:7], s29 offen lds
    v_mfma_f32_32x32x16_bf16 v[80:95], v[28:31], v[16:19], v[80:95]
    v_mfma_f32_32x32x16_bf16 v[96:111], v[24:27], v[20:23], v[96:111]
    s_add_u32 m0, s28, 68608
    s_nop 0
    buffer_load_dwordx4 v5, s[4:7], s29 offen lds
    s_add_u32 s29, s29, 128
    s_cmp_eq_u32 s29, 1280
    s_cselect_b32 s29, 0, s29
    v_mfma_f32_32x32x16_bf16 v[112:127], v[28:31], v[20:23], v[112:127]
    ds_read_b128 v[16:19], v6 offset:32768
    ds_read_b128 v[20:23], v6 offset:36864
    ds_read_b64_tr_b16 v[24:25], v8 offset:16384
    ds_read_b64_tr_b16 v[26:27], v8 offset:16896
    ds_read_b64_tr_b16 v[28:29], v8 offset:24576
    ds_read_b64_tr_b16 v[30:31], v8 offset:25088
    s_waitcnt lgkmcnt(6)
    v_mfma_f32_32x32x16_bf16 v[64:79], v[40:43], v[32:35], v[64:79]
    v_mfma_f32_32x32x16_bf16 v[80:95], v[44:47], v[32:35], v[80:95]
    v_mfma_f32_32x32x16_bf16 v[96:111], v[40:43], v[36:39], v[96:111]
    v_mfma_f32_32x32x16_bf16 v[112:127], v[44:47], v[36:39], v[112:127]
    ds_read_b128 v[32:35], v7 offset:32768
    ds_read_b128 v[36:39], v7 offset:36864
    ds_read_b64_tr_b16 v[40:41], v8 offset:18432
    ds_read_b64_tr_b16 v[42:43], v8 offset:18944
    ds_read_b64_tr_b16 v[44:45], v8 offset:26624
    ds_read_b64_tr_b16 v[46:47], v8 offset:27136
    s_waitcnt vmcnt(0)
    s_barrier
    s_waitcnt lgkmcnt(6)
    v_mfma_f32_32x32x16_bf16 v[64:79], v[24:27], v[16:19], v[64:79]
    s_add_u32 m0, s38, 98304
    s_nop 0
    buffer_load_dwordx4 v10, s[8:11], s30 offen lds
    v_mfma_f32_32x32x16_bf16 v[80:95], v[28:31], v[16:19], v[80:95]
    v_mfma_f32_32x32x16_bf16 v[96:111], v[24:27], v[20:23], v[96:111]
    s_add_u32 m0, s38, 99328
    s_nop 0
    buffer_load_dwordx4 v11, s[8:11], s30 offen lds
    s_add_u32 s30, s30, 81920
    s_cmp_eq_u32 s30, 819200
    s_cselect_b32 s30, 0, s30
    v_mfma_f32_32x32x16_bf16 v[112:127], v[28:31], v[20:23], v[112:127]
    ds_read_b128 v[16:19], v14 offset:32768
    ds_read_b128 v[20:23], v14 offset:36864
    ds_read_b64_tr_b16 v[24:25], v8 offset:20480
    ds_read_b64_tr_b16 v[26:27], v8 offset:20992
    ds_read_b64_tr_b16 v[28:29], v8 offset:28672
    ds_read_b64_tr_b16 v[30:31], v8 offset:29184
    s_waitcnt lgkmcnt(6)
    v_mfma_f32_32x32x16_bf16 v[64:79], v[40:43], v[32:35], v[64:79]
    s_add_u32 m0, s28, 0
    s_nop 0
    buffer_load_dwordx4 v2, s[4:7], s29 offen lds
    v_mfma_f32_32x32x16_bf16 v[80:95], v[44:47], v[32:35], v[80:95]
    v_mfma_f32_32x32x16_bf16 v[96:111], v[40:43], v[36:39], v[96:111]
    s_add_u32 m0, s28, 1024
    s_nop 0
    buffer_load_dwordx4 v3, s[4:7], s29 offen lds
    v_mfma_f32_32x32x16_bf16 v[112:127], v[44:47], v[36:39], v[112:127]
    ds_read_b128 v[32:35], v15 offset:32768
    ds_read_b128 v[36:39], v15 offset:36864
    ds_read_b64_tr_b16 v[40:41], v8 offset:22528
    ds_read_b64_tr_b16 v[42:43], v8 offset:23040
    ds_read_b64_tr_b16 v[44:45], v8 offset:30720
    ds_read_b64_tr_b16 v[46:47], v8 offset:31232
    s_waitcnt lgkmcnt(6)
    v_mfma_f32_32x32x16_bf16 v[64:79], v[24:27], v[16:19], v[64:79]
    s_add_u32 m0, s28, 2048
    s_nop 0
    buffer_load_dwordx4 v4, s[4:7], s29 offen lds
    v_mfma_f32_32x32x16_bf16 v[80:95], v[28:31], v[16:19], v[80:95]
    v_mfma_f32_32x32x16_bf16 v[96:111], v[24:27], v[20:23], v[96:111]
    s_add_u32 m0, s28, 3072
    s_nop 0
    buffer_load_dwordx4 v5, s[4:7], s29 offen lds
    s_add_u32 s29, s29, 128
    s_cmp_eq_u32 s29, 1280
    s_cselect_b32 s29, 0, s29
    v_mfma_f32_32x32x16_bf16 v[112:127], v[28:31], v[20:23], v[112:127]
    ds_read_b128 v[16:19], v48 offset:0
    ds_read_b128 v[20:23], v48 offset:4096
    ds_read_b64_tr_b16 v[24:25], v8 offset:32768
    ds_read_b64_tr_b16 v[26:27], v8 offset:33280
    ds_read_b64_tr_b16 v[28:29], v8 offset:40960
    ds_read_b64_tr_b16 v[30:31], v8 offset:41472
    s_waitcnt lgkmcnt(6)
    v_mfma_f32_32x32x16_bf16 v[64:79], v[40:43], v[32:35], v[64:79]
    v_mfma_f32_32x32x16_bf16 v[80:95], v[44:47], v[32:35], v[80:95]
    v_mfma_f32_32x32x16_bf16 v[96:111], v[40:43], v[36:39], v[96:111]
    v_mfma_f32_32x32x16_bf16 v[112:127], v[44:47], v[36:39], v[112:127]
    ds_read_b128 v[32:35], v49 offset:0
    ds_read_b128 v[36:39], v49 offset:4096
    ds_read_b64_tr_b16 v[40:41], v8 offset:34816
    ds_read_b64_tr_b16 v[42:43], v8 offset:35328
    ds_read_b64_tr_b16 v[44:45], v8 offset:43008
    ds_read_b64_tr_b16 v[46:47], v8 offset:43520
    s_waitcnt vmcnt(0)
    s_barrier
    s_waitcnt lgkmcnt(6)
    v_mfma_f32_32x32x16_bf16 v[64:79], v[24:27], v[16:19], v[64:79]
    v_mfma_f32_32x32x16_bf16 v[80:95], v[28:31], v[16:19], v[80:95]
    v_mfma_f32_32x32x16_bf16 v[96:111], v[24:27], v[20:23], v[96:111]
    v_mfma_f32_32x32x16_bf16 v[112:127], v[28:31], v[20:23], v[112:127]
    ds_read_b128 v[16:19], v50 offset:0
    ds_read_b128 v[20:23], v50 offset:4096
    ds_read_b64_tr_b16 v[24:25], v8 offset:36864
    ds_read_b64_tr_b16 v[26:27], v8 offset:37376
    ds_read_b64_tr_b16 v[28:29], v8 offset:45056
    ds_read_b64_tr_b16 v[30:31], v8 offset:45568
    s_waitcnt lgkmcnt(6)
    v_mfma_f32_32x32x16_bf16 v[64:79], v[40:43], v[32:35], v[64:79]
    v_mfma_f32_32x32x16_bf16 v[80:95], v[44:47], v[32:35], v[80:95]
    v_mfma_f32_32x32x16_bf16 v[96:111], v[40:43], v[36:39], v[96:111]
    v_mfma_f32_32x32x16_bf16 v[112:127], v[44:47], v[36:39], v[112:127]
    ds_read_b128 v[32:35], v51 offset:0
    ds_read_b128 v[36:39], v51 offset:4096
    ds_read_b64_tr_b16 v[40:41], v8 offset:38912
    ds_read_b64_tr_b16 v[42:43], v8 offset:39424
    ds_read_b64_tr_b16 v[44:45], v8 offset:47104
    ds_read_b64_tr_b16 v[46:47], v8 offset:47616
    s_waitcnt lgkmcnt(6)
    v_mfma_f32_32x32x16_bf16 v[64:79], v[24:27], v[16:19], v[64:79]
    v_mfma_f32_32x32x16_bf16 v[80:95], v[28:31], v[16:19], v[80:95]
    v_mfma_f32_32x32x16_bf16 v[96:111], v[24:27], v[20:23], v[96:111]
    v_mfma_f32_32x32x16_bf16 v[112:127], v[28:31], v[20:23], v[112:127]
    ds_read_b128 v[16:19], v6 offset:0
    ds_read_b128 v[20:23], v6 offset:4096
    ds_read_b64_tr_b16 v[24:25], v8 offset:0
    ds_read_b64_tr_b16 v[26:27], v8 offset:512
    ds_read_b64_tr_b16 v[28:29], v8 offset:8192
    ds_read_b64_tr_b16 v[30:31], v8 offset:8704
    s_waitcnt lgkmcnt(6)
    v_mfma_f32_32x32x16_bf16 v[64:79], v[40:43], v[32:35], v[64:79]
    v_mfma_f32_32x32x16_bf16 v[80:95], v[44:47], v[32:35], v[80:95]
    v_mfma_f32_32x32x16_bf16 v[96:111], v[40:43], v[36:39], v[96:111]
    v_mfma_f32_32x32x16_bf16 v[112:127], v[44:47], v[36:39], v[112:127]
    ds_read_b128 v[32:35], v7 offset:0
    ds_read_b128 v[36:39], v7 offset:4096
    ds_read_b64_tr_b16 v[40:41], v8 offset:2048
    ds_read_b64_tr_b16 v[42:43], v8 offset:2560
    ds_read_b64_tr_b16 v[44:45], v8 offset:10240
    ds_read_b64_tr_b16 v[46:47], v8 offset:10752
    s_waitcnt lgkmcnt(6)
    v_mfma_f32_32x32x16_bf16 v[64:79], v[24:27], v[16:19], v[64:79]
    v_mfma_f32_32x32x16_bf16 v[80:95], v[28:31], v[16:19], v[80:95]
    v_mfma_f32_32x32x16_bf16 v[96:111], v[24:27], v[20:23], v[96:111]
    v_mfma_f32_32x32x16_bf16 v[112:127], v[28:31], v[20:23], v[112:127]
    ds_read_b128 v[16:19], v14 offset:0
    ds_read_b128 v[20:23], v14 offset:4096
    ds_read_b64_tr_b16 v[24:25], v8 offset:4096
    ds_read_b64_tr_b16 v[26:27], v8 offset:4608
    ds_read_b64_tr_b16 v[28:29], v8 offset:12288
    ds_read_b64_tr_b16 v[30:31], v8 offset:12800
    s_waitcnt lgkmcnt(6)
    v_mfma_f32_32x32x16_bf16 v[64:79], v[40:43], v[32:35], v[64:79]
    v_mfma_f32_32x32x16_bf16 v[80:95], v[44:47], v[32:35], v[80:95]
    v_mfma_f32_32x32x16_bf16 v[96:111], v[40:43], v[36:39], v[96:111]
    v_mfma_f32_32x32x16_bf16 v[112:127], v[44:47], v[36:39], v[112:127]
    ds_read_b128 v[32:35], v15 offset:0
    ds_read_b128 v[36:39], v15 offset:4096
    ds_read_b64_tr_b16 v[40:41], v8 offset:6144
    ds_read_b64_tr_b16 v[42:43], v8 offset:6656
    ds_read_b64_tr_b16 v[44:45], v8 offset:14336
    ds_read_b64_tr_b16 v[46:47], v8 offset:14848
    s_waitcnt lgkmcnt(6)
    v_mfma_f32_32x32x16_bf16 v[64:79], v[24:27], v[16:19], v[64:79]
    v_mfma_f32_32x32x16_bf16 v[80:95], v[28:31], v[16:19], v[80:95]
    v_mfma_f32_32x32x16_bf16 v[96:111], v[24:27], v[20:23], v[96:111]
    v_mfma_f32_32x32x16_bf16 v[112:127], v[28:31], v[20:23], v[112:127]
    s_waitcnt lgkmcnt(0)
    v_mfma_f32_32x32x16_bf16 v[64:79], v[40:43], v[32:35], v[64:79]
    v_mfma_f32_32x32x16_bf16 v[80:95], v[44:47], v[32:35], v[80:95]
    v_mfma_f32_32x32x16_bf16 v[96:111], v[40:43], v[36:39], v[96:111]
    v_mfma_f32_32x32x16_bf16 v[112:127], v[44:47], v[36:39], v[112:127]
    s_nop 7
    s_nop 7
    s_add_u32 s16, s98, 0
    s_addc_u32 s17, s99, 0
    s_mov_b32 s18, 2621440
    s_mov_b32 s19, 0x00020000
    s_and_b32 s26, s20, 3
    s_lshl_b32 s26, s26, 6
    v_and_b32 v1, 31, v0
    v_add_u32 v1, s26, v1
    v_lshlrev_b32 v2, 7, v1
    s_lshr_b32 s26, s20, 2
    s_lshl_b32 s26, s26, 2
    v_lshrrev_b32 v1, 5, v0
    v_add_u32 v1, s26, v1
    v_and_b32 v3, 7, v0
    v_xor_b32 v1, v1, v3
    v_lshl_add_u32 v2, v1, 4, v2
    v_xor_b32 v3, 32, v2
    s_lshl_b32 s26, s20, 5
    s_add_u32 s26, s26, s21
    v_lshrrev_b32 v1, 3, v0
    v_add_u32 v4, s26, v1
    v_mul_u32_u24 v4, 1280, v4
    v_xor_b32 v1, v1, v0
    v_and_b32 v1, 7, v1
    v_lshl_add_u32 v4, v1, 4, v4
    v_add_u32 v4, s22, v4
    s_lshl_b32 s26, s20, 12
    v_lshlrev_b32 v5, 4, v0
    v_add_u32 v5, s26, v5
    s_mov_b32 s26, 0x3ea52b5c
    s_barrier
    v_mul_f32 v64, s26, v64
    v_mul_f32 v65, s26, v65
    v_mul_f32 v66, s26, v66
    v_mul_f32 v67, s26, v67
    v_mul_f32 v68, s26, v68
    v_mul_f32 v69, s26, v69
    v_mul_f32 v70, s26, v70
    v_mul_f32 v71, s26, v71
    v_cvt_pk_bf16_f32 v16, v64, v65
    v_cvt_pk_bf16_f32 v17, v66, v67
    v_cvt_pk_bf16_f32 v18, v68, v69
    v_cvt_pk_bf16_f32 v19, v70, v71
    ds_write_b128 v2, v[16:19] offset:0
    v_mul_f32 v72, s26, v72
    v_mul_f32 v73, s26, v73
    v_mul_f32 v74, s26, v74
    v_mul_f32 v75, s26, v75
    v_mul_f32 v76, s26, v76
    v_mul_f32 v77, s26, v77
    v_mul_f32 v78, s26, v78
    v_mul_f32 v79, s26, v79
    v_cvt_pk_bf16_f32 v20, v72, v73
    v_cvt_pk_bf16_f32 v21, v74, v75
    v_cvt_pk_bf16_f32 v22, v76, v77
    v_cvt_pk_bf16_f32 v23, v78, v79
    ds_write_b128 v3, v[20:23] offset:0
    v_mul_f32 v80, s26, v80
    v_mul_f32 v81, s26, v81
    v_mul_f32 v82, s26, v82
    v_mul_f32 v83, s26, v83
    v_mul_f32 v84, s26, v84
    v_mul_f32 v85, s26, v85
    v_mul_f32 v86, s26, v86
    v_mul_f32 v87, s26, v87
    v_cvt_pk_bf16_f32 v24, v80, v81
    v_cvt_pk_bf16_f32 v25, v82, v83
    v_cvt_pk_bf16_f32 v26, v84, v85
    v_cvt_pk_bf16_f32 v27, v86, v87
    ds_write_b128 v2, v[24:27] offset:32768
    v_mul_f32 v88, s26, v88
    v_mul_f32 v89, s26, v89
    v_mul_f32 v90, s26, v90
    v_mul_f32 v91, s26, v91
    v_mul_f32 v92, s26, v92
    v_mul_f32 v93, s26, v93
    v_mul_f32 v94, s26, v94
    v_mul_f32 v95, s26, v95
    v_cvt_pk_bf16_f32 v28, v88, v89
    v_cvt_pk_bf16_f32 v29, v90, v91
    v_cvt_pk_bf16_f32 v30, v92, v93
    v_cvt_pk_bf16_f32 v31, v94, v95
    ds_write_b128 v3, v[28:31] offset:32768
    v_mul_f32 v96, s26, v96
    v_mul_f32 v97, s26, v97
    v_mul_f32 v98, s26, v98
    v_mul_f32 v99, s26, v99
    v_mul_f32 v100, s26, v100
    v_mul_f32 v101, s26, v101
    v_mul_f32 v102, s26, v102
    v_mul_f32 v103, s26, v103
    v_cvt_pk_bf16_f32 v32, v96, v97
    v_cvt_pk_bf16_f32 v33, v98, v99
    v_cvt_pk_bf16_f32 v34, v100, v101
    v_cvt_pk_bf16_f32 v35, v102, v103
    ds_write_b128 v2, v[32:35] offset:4096
    v_mul_f32 v104, s26, v104
    v_mul_f32 v105, s26, v105
    v_mul_f32 v106, s26, v106
    v_mul_f32 v107, s26, v107
    v_mul_f32 v108, s26, v108
    v_mul_f32 v109, s26, v109
    v_mul_f32 v110, s26, v110
    v_mul_f32 v111, s26, v111
    v_cvt_pk_bf16_f32 v36, v104, v105
    v_cvt_pk_bf16_f32 v37, v106, v107
    v_cvt_pk_bf16_f32 v38, v108, v109
    v_cvt_pk_bf16_f32 v39, v110, v111
    ds_write_b128 v3, v[36:39] offset:4096
    v_mul_f32 v112, s26, v112
    v_mul_f32 v113, s26, v113
    v_mul_f32 v114, s26, v114
    v_mul_f32 v115, s26, v115
    v_mul_f32 v116, s26, v116
    v_mul_f32 v117, s26, v117
    v_mul_f32 v118, s26, v118
    v_mul_f32 v119, s26, v119
    v_cvt_pk_bf16_f32 v40, v112, v113
    v_cvt_pk_bf16_f32 v41, v114, v115
    v_cvt_pk_bf16_f32 v42, v116, v117
    v_cvt_pk_bf16_f32 v43, v118, v119
    ds_write_b128 v2, v[40:43] offset:36864
    v_mul_f32 v120, s26, v120
    v_mul_f32 v121, s26, v121
    v_mul_f32 v122, s26, v122
    v_mul_f32 v123, s26, v123
    v_mul_f32 v124, s26, v124
    v_mul_f32 v125, s26, v125
    v_mul_f32 v126, s26, v126
    v_mul_f32 v127, s26, v127
    v_cvt_pk_bf16_f32 v44, v120, v121
    v_cvt_pk_bf16_f32 v45, v122, v123
    v_cvt_pk_bf16_f32 v46, v124, v125
    v_cvt_pk_bf16_f32 v47, v126, v127
    ds_write_b128 v3, v[44:47] offset:36864
    s_waitcnt lgkmcnt(0)
    s_barrier
    ds_read_b128 v[64:67], v5 offset:0
    ds_read_b128 v[68:71], v5 offset:1024
    ds_read_b128 v[72:75], v5 offset:2048
    ds_read_b128 v[76:79], v5 offset:3072
    ds_read_b128 v[80:83], v5 offset:32768
    ds_read_b128 v[84:87], v5 offset:33792
    ds_read_b128 v[88:91], v5 offset:34816
    ds_read_b128 v[92:95], v5 offset:35840
    s_waitcnt lgkmcnt(7)
    s_mov_b32 s26, 0
    buffer_store_dwordx4 v[64:67], v4, s[16:19], s26 offen offset:0 sc1
    s_waitcnt lgkmcnt(6)
    s_mov_b32 s26, 10240
    buffer_store_dwordx4 v[68:71], v4, s[16:19], s26 offen offset:0 sc1
    s_waitcnt lgkmcnt(5)
    s_mov_b32 s26, 20480
    buffer_store_dwordx4 v[72:75], v4, s[16:19], s26 offen offset:0 sc1
    s_waitcnt lgkmcnt(4)
    s_mov_b32 s26, 30720
    buffer_store_dwordx4 v[76:79], v4, s[16:19], s26 offen offset:0 sc1
    s_waitcnt lgkmcnt(3)
    s_mov_b32 s26, 0
    buffer_store_dwordx4 v[80:83], v4, s[16:19], s26 offen offset:128 sc1
    s_waitcnt lgkmcnt(2)
    s_mov_b32 s26, 10240
    buffer_store_dwordx4 v[84:87], v4, s[16:19], s26 offen offset:128 sc1
    s_waitcnt lgkmcnt(1)
    s_mov_b32 s26, 20480
    buffer_store_dwordx4 v[88:91], v4, s[16:19], s26 offen offset:128 sc1
    s_waitcnt lgkmcnt(0)
    s_mov_b32 s26, 30720
    buffer_store_dwordx4 v[92:95], v4, s[16:19], s26 offen offset:128 sc1
    s_endpgm
Lp_kv:
    s_sub_u32 s3, s2, 232
    s_and_b32 s26, s3, 1
    s_lshl_b32 s26, s26, 4
    s_bfe_u32 s27, s3, 0x20001
    s_lshl_b32 s27, s27, 2
    s_add_u32 s26, s26, s27
    s_lshr_b32 s27, s3, 3
    s_lshl_b32 s27, s27, 1
    s_add_u32 s21, s26, s27
    s_lshr_b32 s39, s20, 2
    s_add_u32 s21, s21, s39
    s_and_b32 s20, s20, 3
    s_lshl_b32 s28, s20, 10
    v_lshlrev_b32 v2, 4, v0
    v_add_u32 v2, s28, v2
    s_lshl_b32 s26, s21, 6
    s_lshl_b32 s27, s20, 4
    s_add_u32 s26, s26, s27
    v_lshrrev_b32 v1, 3, v0
    v_add_u32 v1, s26, v1
    v_mul_u32_u24 v10, 1280, v1
    v_lshrrev_b32 v1, 4, v0
    v_xor_b32 v1, v1, v0
    v_and_b32 v1, 7, v1
    v_xor_b32 v9, 4, v1
    v_add_u32 v11, 10240, v10
    v_lshl_add_u32 v10, v1, 4, v10
    v_lshl_add_u32 v11, v9, 4, v11
    s_lshl_b32 s31, s20, 11
    s_mul_i32 s39, s39, 24576
    s_add_u32 s31, s31, s39
    s_waitcnt lgkmcnt(0)
    s_mov_b32 s4, s64
    s_mov_b32 s5, s65
    s_mov_b32 s6, 2621440
    s_mov_b32 s7, 0x00020000
    s_mov_b32 s8, s68
    s_mov_b32 s9, s69
    s_mov_b32 s10, 25600
    s_mov_b32 s11, 0x00020000
    s_mov_b32 s12, s70
    s_mov_b32 s13, s71
    s_mov_b32 s14, 25600
    s_mov_b32 s15, 0x00020000
    s_mov_b32 s16, s82
    s_mov_b32 s17, s83
    s_mov_b32 s18, 1280
    s_mov_b32 s19, 0x00020000
    s_add_u32 m0, s28, 0
    s_mov_b32 s29, 0
    buffer_load_dwordx4 v2, s[8:11], s29 offen lds
    s_add_u32 m0, s28, 25600
    s_nop 0
    buffer_load_dwordx4 v2, s[12:15], s29 offen lds
    s_add_u32 m0, s28, 4096
    s_mov_b32 s29, 4096
    buffer_load_dwordx4 v2, s[8:11], s29 offen lds
    s_add_u32 m0, s28, 29696
    s_nop 0
    buffer_load_dwordx4 v2, s[12:15], s29 offen lds
    s_add_u32 m0, s28, 8192
    s_mov_b32 s29, 8192
    buffer_load_dwordx4 v2, s[8:11], s29 offen lds
    s_add_u32 m0, s28, 33792
    s_nop 0
    buffer_load_dwordx4 v2, s[12:15], s29 offen lds
    s_add_u32 m0, s28, 12288
    s_mov_b32 s29, 12288
    buffer_load_dwordx4 v2, s[8:11], s29 offen lds
    s_add_u32 m0, s28, 37888
    s_nop 0
    buffer_load_dwordx4 v2, s[12:15], s29 offen lds
    s_add_u32 m0, s28, 16384
    s_mov_b32 s29, 16384
    buffer_load_dwordx4 v2, s[8:11], s29 offen lds
    s_add_u32 m0, s28, 41984
    s_nop 0
    buffer_load_dwordx4 v2, s[12:15], s29 offen lds
    s_add_u32 m0, s28, 20480
    s_mov_b32 s29, 20480
    buffer_load_dwordx4 v2, s[8:11], s29 offen lds
    s_add_u32 m0, s28, 46080
    s_nop 0
    buffer_load_dwordx4 v2, s[12:15], s29 offen lds
    s_cmp_ge_u32 s20, 2
    s_cbranch_scc1 Lkv_a
    s_add_u32 m0, s28, 51200
    s_nop 0
    buffer_load_dwordx4 v2, s[16:19], 0 offen lds
    s_cmp_ge_u32 s20, 1
    s_cbranch_scc1 Lkv_a
    s_mov_b32 m0, 24576
    s_mov_b32 s29, 24576
    buffer_load_dwordx4 v2, s[8:11], s29 offen lds
    s_mov_b32 m0, 50176
    s_nop 0
    buffer_load_dwordx4 v2, s[12:15], s29 offen lds
Lkv_a:
    s_add_u32 m0, s31, 53248
    s_mov_b32 s29, 0
    buffer_load_dwordx4 v10, s[4:7], s29 offen lds
    s_add_u32 m0, s31, 54272
    s_mov_b32 s29, 0
    buffer_load_dwordx4 v11, s[4:7], s29 offen lds
    s_add_u32 m0, s31, 61440
    s_mov_b32 s29, 128
    buffer_load_dwordx4 v10, s[4:7], s29 offen lds
    s_add_u32 m0, s31, 62464
    s_mov_b32 s29, 128
    buffer_load_dwordx4 v11, s[4:7], s29 offen lds
    s_and_b32 s23, s20, 1
    s_lshr_b32 s24, s20, 1
    s_lshl_b32 s26, s21, 1
    s_add_u32 s26, s26, s23
    v_lshrrev_b32 v9, 5, v0
    v_lshlrev_b32 v4, 3, v9
    v_bfe_u32 v5, v0, 2, 2
    v_add_u32 v4, v4, v5
    v_mul_u32_u24 v4, 40, v4
    v_bfe_u32 v5, v0, 4, 1
    v_lshl_add_u32 v4, v5, 5, v4
    s_mul_i32 s27, s24, 1280
    v_add_u32 v4, s27, v4
    v_and_b32 v5, 3, v0
    v_lshl_add_u32 v7, v5, 3, v4
    v_add_u32 v7, 25600, v7
    v_and_b32 v5, 1, v0
    v_lshlrev_b32 v5, 1, v5
    v_bfe_u32 v6, v0, 1, 1
    v_or_b32 v5, v5, v6
    v_lshl_add_u32 v6, v5, 3, v4
    s_lshl_b32 s27, s24, 6
    v_lshlrev_b32 v8, 4, v9
    v_add_u32 v8, s27, v8
    v_add_u32 v8, 51200, v8
    s_lshl_b32 s27, s23, 5
    v_and_b32 v1, 31, v0
    v_add_u32 v1, s27, v1
    v_lshlrev_b32 v12, 7, v1
    s_lshl_b32 s27, s24, 2
    v_add_u32 v1, s27, v9
    v_bfe_u32 v5, v0, 1, 3
    v_xor_b32 v1, v1, v5
    v_lshl_add_u32 v12, v1, 4, v12
    v_add_u32 v12, 53248, v12
    v_add_u32 v12, s39, v12
    v_xor_b32 v13, 32, v12
    v_mov_b32 v16, 0
    v_mov_b32 v17, 0
    v_mov_b32 v18, 0
    v_mov_b32 v19, 0
    v_mov_b32 v20, 0
    v_mov_b32 v21, 0
    v_mov_b32 v22, 0
    v_mov_b32 v23, 0
    v_mov_b32 v24, 0
    v_mov_b32 v25, 0
    v_mov_b32 v26, 0
    v_mov_b32 v27, 0
    v_mov_b32 v28, 0
    v_mov_b32 v29, 0
    v_mov_b32 v30, 0
    v_mov_b32 v31, 0
    v_mov_b32 v32, 0
    v_mov_b32 v33, 0
    v_mov_b32 v34, 0
    v_mov_b32 v35, 0
    v_mov_b32 v36, 0
    v_mov_b32 v37, 0
    v_mov_b32 v38, 0
    v_mov_b32 v39, 0
    v_mov_b32 v40, 0
    v_mov_b32 v41, 0
    v_mov_b32 v42, 0
    v_mov_b32 v43, 0
    v_mov_b32 v44, 0
    v_mov_b32 v45, 0
    v_mov_b32 v46, 0
    v_mov_b32 v47, 0
    v_mov_b32 v48, 0
    v_mov_b32 v49, 0
    v_mov_b32 v50, 0
    v_mov_b32 v51, 0
    v_mov_b32 v52, 0
    v_mov_b32 v53, 0
    v_mov_b32 v54, 0
    v_mov_b32 v55, 0
    v_mov_b32 v56, 0
    v_mov_b32 v57, 0
    v_mov_b32 v58, 0
    v_mov_b32 v59, 0
    v_mov_b32 v60, 0
    v_mov_b32 v61, 0
    v_mov_b32 v62, 0
    v_mov_b32 v63, 0
    s_waitcnt vmcnt(2)
    s_barrier
    s_add_u32 m0, s31, 69632
    s_mov_b32 s29, 256
    buffer_load_dwordx4 v10, s[4:7], s29 offen lds
    s_add_u32 m0, s31, 70656
    s_mov_b32 s29, 256
    buffer_load_dwordx4 v11, s[4:7], s29 offen lds
    ds_read_b64_tr_b16 v[64:65], v6 offset:0
    ds_read_b64_tr_b16 v[66:67], v6 offset:160
    ds_read_b64_tr_b16 v[68:69], v7 offset:0
    ds_read_b64_tr_b16 v[70:71], v7 offset:160
    ds_read_b128 v[72:75], v8 offset:0
    ds_read_b128 v[76:79], v12 offset:0
    ds_read_b64_tr_b16 v[80:81], v6 offset:640
    ds_read_b64_tr_b16 v[82:83], v6 offset:800
    ds_read_b64_tr_b16 v[84:85], v7 offset:640
    ds_read_b64_tr_b16 v[86:87], v7 offset:800
    ds_read_b128 v[88:91], v8 offset:32
    ds_read_b128 v[92:95], v13 offset:0
    s_waitcnt lgkmcnt(6)
    v_mfma_f32_32x32x16_bf16 v[16:31], v[64:67], v[76:79], v[16:31]
    v_mfma_f32_32x32x16_bf16 v[32:47], v[76:79], v[68:71], v[32:47]
    v_mfma_f32_32x32x16_bf16 v[48:63], v[72:75], v[76:79], v[48:63]
    s_waitcnt lgkmcnt(0)
    v_mfma_f32_32x32x16_bf16 v[16:31], v[80:83], v[92:95], v[16:31]
    v_mfma_f32_32x32x16_bf16 v[32:47], v[92:95], v[84:87], v[32:47]
    v_mfma_f32_32x32x16_bf16 v[48:63], v[88:91], v[92:95], v[48:63]
    s_waitcnt vmcnt(2)
    s_barrier
    s_add_u32 m0, s31, 53248
    s_mov_b32 s29, 384
    buffer_load_dwordx4 v10, s[4:7], s29 offen lds
    s_add_u32 m0, s31, 54272
    s_mov_b32 s29, 384
    buffer_load_dwordx4 v11, s[4:7], s29 offen lds
    ds_read_b64_tr_b16 v[64:65], v6 offset:2560
    ds_read_b64_tr_b16 v[66:67], v6 offset:2720
    ds_read_b64_tr_b16 v[68:69], v7 offset:2560
    ds_read_b64_tr_b16 v[70:71], v7 offset:2720
    ds_read_b128 v[72:75], v8 offset:128
    ds_read_b128 v[76:79], v12 offset:8192
    ds_read_b64_tr_b16 v[80:81], v6 offset:3200
    ds_read_b64_tr_b16 v[82:83], v6 offset:3360
    ds_read_b64_tr_b16 v[84:85], v7 offset:3200
    ds_read_b64_tr_b16 v[86:87], v7 offset:3360
    ds_read_b128 v[88:91], v8 offset:160
    ds_read_b128 v[92:95], v13 offset:8192
    s_waitcnt lgkmcnt(6)
    v_mfma_f32_32x32x16_bf16 v[16:31], v[64:67], v[76:79], v[16:31]
    v_mfma_f32_32x32x16_bf16 v[32:47], v[76:79], v[68:71], v[32:47]
    v_mfma_f32_32x32x16_bf16 v[48:63], v[72:75], v[76:79], v[48:63]
    s_waitcnt lgkmcnt(0)
    v_mfma_f32_32x32x16_bf16 v[16:31], v[80:83], v[92:95], v[16:31]
    v_mfma_f32_32x32x16_bf16 v[32:47], v[92:95], v[84:87], v[32:47]
    v_mfma_f32_32x32x16_bf16 v[48:63], v[88:91], v[92:95], v[48:63]
    s_waitcnt vmcnt(2)
    s_barrier
    s_add_u32 m0, s31, 61440
    s_mov_b32 s29, 512
    buffer_load_dwordx4 v10, s[4:7], s29 offen lds
    s_add_u32 m0, s31, 62464
    s_mov_b32 s29, 512
    buffer_load_dwordx4 v11, s[4:7], s29 offen lds
    ds_read_b64_tr_b16 v[64:65], v6 offset:5120
    ds_read_b64_tr_b16 v[66:67], v6 offset:5280
    ds_read_b64_tr_b16 v[68:69], v7 offset:5120
    ds_read_b64_tr_b16 v[70:71], v7 offset:5280
    ds_read_b128 v[72:75], v8 offset:256
    ds_read_b128 v[76:79], v12 offset:16384
    ds_read_b64_tr_b16 v[80:81], v6 offset:5760
    ds_read_b64_tr_b16 v[82:83], v6 offset:5920
    ds_read_b64_tr_b16 v[84:85], v7 offset:5760
    ds_read_b64_tr_b16 v[86:87], v7 offset:5920
    ds_read_b128 v[88:91], v8 offset:288
    ds_read_b128 v[92:95], v13 offset:16384
    s_waitcnt lgkmcnt(6)
    v_mfma_f32_32x32x16_bf16 v[16:31], v[64:67], v[76:79], v[16:31]
    v_mfma_f32_32x32x16_bf16 v[32:47], v[76:79], v[68:71], v[32:47]
    v_mfma_f32_32x32x16_bf16 v[48:63], v[72:75], v[76:79], v[48:63]
    s_waitcnt lgkmcnt(0)
    v_mfma_f32_32x32x16_bf16 v[16:31], v[80:83], v[92:95], v[16:31]
    v_mfma_f32_32x32x16_bf16 v[32:47], v[92:95], v[84:87], v[32:47]
    v_mfma_f32_32x32x16_bf16 v[48:63], v[88:91], v[92:95], v[48:63]
    s_waitcnt vmcnt(2)
    s_barrier
    s_add_u32 m0, s31, 69632
    s_mov_b32 s29, 640
    buffer_load_dwordx4 v10, s[4:7], s29 offen lds
    s_add_u32 m0, s31, 70656
    s_mov_b32 s29, 640
    buffer_load_dwordx4 v11, s[4:7], s29 offen lds
    ds_read_b64_tr_b16 v[64:65], v6 offset:7680
    ds_read_b64_tr_b16 v[66:67], v6 offset:7840
    ds_read_b64_tr_b16 v[68:69], v7 offset:7680
    ds_read_b64_tr_b16 v[70:71], v7 offset:7840
    ds_read_b128 v[72:75], v8 offset:384
    ds_read_b128 v[76:79], v12 offset:0
    ds_read_b64_tr_b16 v[80:81], v6 offset:8320
    ds_read_b64_tr_b16 v[82:83], v6 offset:8480
    ds_read_b64_tr_b16 v[84:85], v7 offset:8320
    ds_read_b64_tr_b16 v[86:87], v7 offset:8480
    ds_read_b128 v[88:91], v8 offset:416
    ds_read_b128 v[92:95], v13 offset:0
    s_waitcnt lgkmcnt(6)
    v_mfma_f32_32x32x16_bf16 v[16:31], v[64:67], v[76:79], v[16:31]
    v_mfma_f32_32x32x16_bf16 v[32:47], v[76:79], v[68:71], v[32:47]
    v_mfma_f32_32x32x16_bf16 v[48:63], v[72:75], v[76:79], v[48:63]
    s_waitcnt lgkmcnt(0)
    v_mfma_f32_32x32x16_bf16 v[16:31], v[80:83], v[92:95], v[16:31]
    v_mfma_f32_32x32x16_bf16 v[32:47], v[92:95], v[84:87], v[32:47]
    v_mfma_f32_32x32x16_bf16 v[48:63], v[88:91], v[92:95], v[48:63]
    s_waitcnt vmcnt(2)
    s_barrier
    s_add_u32 m0, s31, 53248
    s_mov_b32 s29, 768
    buffer_load_dwordx4 v10, s[4:7], s29 offen lds
    s_add_u32 m0, s31, 54272
    s_mov_b32 s29, 768
    buffer_load_dwordx4 v11, s[4:7], s29 offen lds
    ds_read_b64_tr_b16 v[64:65], v6 offset:10240
    ds_read_b64_tr_b16 v[66:67], v6 offset:10400
    ds_read_b64_tr_b16 v[68:69], v7 offset:10240
    ds_read_b64_tr_b16 v[70:71], v7 offset:10400
    ds_read_b128 v[72:75], v8 offset:512
    ds_read_b128 v[76:79], v12 offset:8192
    ds_read_b64_tr_b16 v[80:81], v6 offset:10880
    ds_read_b64_tr_b16 v[82:83], v6 offset:11040
    ds_read_b64_tr_b16 v[84:85], v7 offset:10880
    ds_read_b64_tr_b16 v[86:87], v7 offset:11040
    ds_read_b128 v[88:91], v8 offset:544
    ds_read_b128 v[92:95], v13 offset:8192
    s_waitcnt lgkmcnt(6)
    v_mfma_f32_32x32x16_bf16 v[16:31], v[64:67], v[76:79], v[16:31]
    v_mfma_f32_32x32x16_bf16 v[32:47], v[76:79], v[68:71], v[32:47]
    v_mfma_f32_32x32x16_bf16 v[48:63], v[72:75], v[76:79], v[48:63]
    s_waitcnt lgkmcnt(0)
    v_mfma_f32_32x32x16_bf16 v[16:31], v[80:83], v[92:95], v[16:31]
    v_mfma_f32_32x32x16_bf16 v[32:47], v[92:95], v[84:87], v[32:47]
    v_mfma_f32_32x32x16_bf16 v[48:63], v[88:91], v[92:95], v[48:63]
    s_waitcnt vmcnt(2)
    s_barrier
    s_add_u32 m0, s31, 61440
    s_mov_b32 s29, 896
    buffer_load_dwordx4 v10, s[4:7], s29 offen lds
    s_add_u32 m0, s31, 62464
    s_mov_b32 s29, 896
    buffer_load_dwordx4 v11, s[4:7], s29 offen lds
    ds_read_b64_tr_b16 v[64:65], v6 offset:12800
    ds_read_b64_tr_b16 v[66:67], v6 offset:12960
    ds_read_b64_tr_b16 v[68:69], v7 offset:12800
    ds_read_b64_tr_b16 v[70:71], v7 offset:12960
    ds_read_b128 v[72:75], v8 offset:640
    ds_read_b128 v[76:79], v12 offset:16384
    ds_read_b64_tr_b16 v[80:81], v6 offset:13440
    ds_read_b64_tr_b16 v[82:83], v6 offset:13600
    ds_read_b64_tr_b16 v[84:85], v7 offset:13440
    ds_read_b64_tr_b16 v[86:87], v7 offset:13600
    ds_read_b128 v[88:91], v8 offset:672
    ds_read_b128 v[92:95], v13 offset:16384
    s_waitcnt lgkmcnt(6)
    v_mfma_f32_32x32x16_bf16 v[16:31], v[64:67], v[76:79], v[16:31]
    v_mfma_f32_32x32x16_bf16 v[32:47], v[76:79], v[68:71], v[32:47]
    v_mfma_f32_32x32x16_bf16 v[48:63], v[72:75], v[76:79], v[48:63]
    s_waitcnt lgkmcnt(0)
    v_mfma_f32_32x32x16_bf16 v[16:31], v[80:83], v[92:95], v[16:31]
    v_mfma_f32_32x32x16_bf16 v[32:47], v[92:95], v[84:87], v[32:47]
    v_mfma_f32_32x32x16_bf16 v[48:63], v[88:91], v[92:95], v[48:63]
    s_waitcnt vmcnt(2)
    s_barrier
    s_add_u32 m0, s31, 69632
    s_mov_b32 s29, 1024
    buffer_load_dwordx4 v10, s[4:7], s29 offen lds
    s_add_u32 m0, s31, 70656
    s_mov_b32 s29, 1024
    buffer_load_dwordx4 v11, s[4:7], s29 offen lds
    ds_read_b64_tr_b16 v[64:65], v6 offset:15360
    ds_read_b64_tr_b16 v[66:67], v6 offset:15520
    ds_read_b64_tr_b16 v[68:69], v7 offset:15360
    ds_read_b64_tr_b16 v[70:71], v7 offset:15520
    ds_read_b128 v[72:75], v8 offset:768
    ds_read_b128 v[76:79], v12 offset:0
    ds_read_b64_tr_b16 v[80:81], v6 offset:16000
    ds_read_b64_tr_b16 v[82:83], v6 offset:16160
    ds_read_b64_tr_b16 v[84:85], v7 offset:16000
    ds_read_b64_tr_b16 v[86:87], v7 offset:16160
    ds_read_b128 v[88:91], v8 offset:800
    ds_read_b128 v[92:95], v13 offset:0
    s_waitcnt lgkmcnt(6)
    v_mfma_f32_32x32x16_bf16 v[16:31], v[64:67], v[76:79], v[16:31]
    v_mfma_f32_32x32x16_bf16 v[32:47], v[76:79], v[68:71], v[32:47]
    v_mfma_f32_32x32x16_bf16 v[48:63], v[72:75], v[76:79], v[48:63]
    s_waitcnt lgkmcnt(0)
    v_mfma_f32_32x32x16_bf16 v[16:31], v[80:83], v[92:95], v[16:31]
    v_mfma_f32_32x32x16_bf16 v[32:47], v[92:95], v[84:87], v[32:47]
    v_mfma_f32_32x32x16_bf16 v[48:63], v[88:91], v[92:95], v[48:63]
    s_waitcnt vmcnt(2)
    s_barrier
    s_add_u32 m0, s31, 53248
    s_mov_b32 s29, 1152
    buffer_load_dwordx4 v10, s[4:7], s29 offen lds
    s_add_u32 m0, s31, 54272
    s_mov_b32 s29, 1152
    buffer_load_dwordx4 v11, s[4:7], s29 offen lds
    ds_read_b64_tr_b16 v[64:65], v6 offset:17920
    ds_read_b64_tr_b16 v[66:67], v6 offset:18080
    ds_read_b64_tr_b16 v[68:69], v7 offset:17920
    ds_read_b64_tr_b16 v[70:71], v7 offset:18080
    ds_read_b128 v[72:75], v8 offset:896
    ds_read_b128 v[76:79], v12 offset:8192
    ds_read_b64_tr_b16 v[80:81], v6 offset:18560
    ds_read_b64_tr_b16 v[82:83], v6 offset:18720
    ds_read_b64_tr_b16 v[84:85], v7 offset:18560
    ds_read_b64_tr_b16 v[86:87], v7 offset:18720
    ds_read_b128 v[88:91], v8 offset:928
    ds_read_b128 v[92:95], v13 offset:8192
    s_waitcnt lgkmcnt(6)
    v_mfma_f32_32x32x16_bf16 v[16:31], v[64:67], v[76:79], v[16:31]
    v_mfma_f32_32x32x16_bf16 v[32:47], v[76:79], v[68:71], v[32:47]
    v_mfma_f32_32x32x16_bf16 v[48:63], v[72:75], v[76:79], v[48:63]
    s_waitcnt lgkmcnt(0)
    v_mfma_f32_32x32x16_bf16 v[16:31], v[80:83], v[92:95], v[16:31]
    v_mfma_f32_32x32x16_bf16 v[32:47], v[92:95], v[84:87], v[32:47]
    v_mfma_f32_32x32x16_bf16 v[48:63], v[88:91], v[92:95], v[48:63]
    s_waitcnt vmcnt(2)
    s_barrier
    ds_read_b64_tr_b16 v[64:65], v6 offset:20480
    ds_read_b64_tr_b16 v[66:67], v6 offset:20640
    ds_read_b64_tr_b16 v[68:69], v7 offset:20480
    ds_read_b64_tr_b16 v[70:71], v7 offset:20640
    ds_read_b128 v[72:75], v8 offset:1024
    ds_read_b128 v[76:79], v12 offset:16384
    ds_read_b64_tr_b16 v[80:81], v6 offset:21120
    ds_read_b64_tr_b16 v[82:83], v6 offset:21280
    ds_read_b64_tr_b16 v[84:85], v7 offset:21120
    ds_read_b64_tr_b16 v[86:87], v7 offset:21280
    ds_read_b128 v[88:91], v8 offset:1056
    ds_read_b128 v[92:95], v13 offset:16384
    s_waitcnt lgkmcnt(6)
    v_mfma_f32_32x32x16_bf16 v[16:31], v[64:67], v[76:79], v[16:31]
    v_mfma_f32_32x32x16_bf16 v[32:47], v[76:79], v[68:71], v[32:47]
    v_mfma_f32_32x32x16_bf16 v[48:63], v[72:75], v[76:79], v[48:63]
    s_waitcnt lgkmcnt(0)
    v_mfma_f32_32x32x16_bf16 v[16:31], v[80:83], v[92:95], v[16:31]
    v_mfma_f32_32x32x16_bf16 v[32:47], v[92:95], v[84:87], v[32:47]
    v_mfma_f32_32x32x16_bf16 v[48:63], v[88:91], v[92:95], v[48:63]
    s_waitcnt vmcnt(0)
    s_barrier
    ds_read_b64_tr_b16 v[64:65], v6 offset:23040
    ds_read_b64_tr_b16 v[66:67], v6 offset:23200
    ds_read_b64_tr_b16 v[68:69], v7 offset:23040
    ds_read_b64_tr_b16 v[70:71], v7 offset:23200
    ds_read_b128 v[72:75], v8 offset:1152
    ds_read_b128 v[76:79], v12 offset:0
    ds_read_b64_tr_b16 v[80:81], v6 offset:23680
    ds_read_b64_tr_b16 v[82:83], v6 offset:23840
    ds_read_b64_tr_b16 v[84:85], v7 offset:23680
    ds_read_b64_tr_b16 v[86:87], v7 offset:23840
    ds_read_b128 v[88:91], v8 offset:1184
    ds_read_b128 v[92:95], v13 offset:0
    s_waitcnt lgkmcnt(6)
    v_mfma_f32_32x32x16_bf16 v[16:31], v[64:67], v[76:79], v[16:31]
    v_mfma_f32_32x32x16_bf16 v[32:47], v[76:79], v[68:71], v[32:47]
    v_mfma_f32_32x32x16_bf16 v[48:63], v[72:75], v[76:79], v[48:63]
    s_waitcnt lgkmcnt(0)
    v_mfma_f32_32x32x16_bf16 v[16:31], v[80:83], v[92:95], v[16:31]
    v_mfma_f32_32x32x16_bf16 v[32:47], v[92:95], v[84:87], v[32:47]
    v_mfma_f32_32x32x16_bf16 v[48:63], v[88:91], v[92:95], v[48:63]
    s_nop 7
    s_nop 7
    s_barrier
    s_mul_i32 s27, s23, 12288
    s_add_u32 s27, s27, s39
    v_lshlrev_b32 v1, 4, v0
    v_add_u32 v1, s27, v1
    s_cmp_eq_u32 s24, 0
    s_cbranch_scc1 Lkv_b
    ds_write_b128 v1, v[16:19] offset:0
    ds_write_b128 v1, v[20:23] offset:1024
    ds_write_b128 v1, v[24:27] offset:2048
    ds_write_b128 v1, v[28:31] offset:3072
    ds_write_b128 v1, v[32:35] offset:4096
    ds_write_b128 v1, v[36:39] offset:5120
    ds_write_b128 v1, v[40:43] offset:6144
    ds_write_b128 v1, v[44:47] offset:7168
    ds_write_b128 v1, v[48:51] offset:8192
    ds_write_b128 v1, v[52:55] offset:9216
    ds_write_b128 v1, v[56:59] offset:10240
    ds_write_b128 v1, v[60:63] offset:11264
    s_waitcnt lgkmcnt(0)
Lkv_b:
    s_barrier
    s_cmp_eq_u32 s24, 0
    s_cbranch_scc0 Lkv_end
    ds_read_b128 v[80:83], v1 offset:0
    ds_read_b128 v[84:87], v1 offset:1024
    ds_read_b128 v[88:91], v1 offset:2048
    ds_read_b128 v[92:95], v1 offset:3072
    ds_read_b128 v[96:99], v1 offset:4096
    ds_read_b128 v[100:103], v1 offset:5120
    ds_read_b128 v[104:107], v1 offset:6144
    ds_read_b128 v[108:111], v1 offset:7168
    ds_read_b128 v[112:115], v1 offset:8192
    ds_read_b128 v[116:119], v1 offset:9216
    ds_read_b128 v[120:123], v1 offset:10240
    ds_read_b128 v[124:127], v1 offset:11264
    s_waitcnt lgkmcnt(0)
    v_add_f32 v16, v16, v80
    v_add_f32 v17, v17, v81
    v_add_f32 v18, v18, v82
    v_add_f32 v19, v19, v83
    v_add_f32 v20, v20, v84
    v_add_f32 v21, v21, v85
    v_add_f32 v22, v22, v86
    v_add_f32 v23, v23, v87
    v_add_f32 v24, v24, v88
    v_add_f32 v25, v25, v89
    v_add_f32 v26, v26, v90
    v_add_f32 v27, v27, v91
    v_add_f32 v28, v28, v92
    v_add_f32 v29, v29, v93
    v_add_f32 v30, v30, v94
    v_add_f32 v31, v31, v95
    v_add_f32 v32, v32, v96
    v_add_f32 v33, v33, v97
    v_add_f32 v34, v34, v98
    v_add_f32 v35, v35, v99
    v_add_f32 v36, v36, v100
    v_add_f32 v37, v37, v101
    v_add_f32 v38, v38, v102
    v_add_f32 v39, v39, v103
    v_add_f32 v40, v40, v104
    v_add_f32 v41, v41, v105
    v_add_f32 v42, v42, v106
    v_add_f32 v43, v43, v107
    v_add_f32 v44, v44, v108
    v_add_f32 v45, v45, v109
    v_add_f32 v46, v46, v110
    v_add_f32 v47, v47, v111
    v_add_f32 v48, v48, v112
    v_add_f32 v49, v49, v113
    v_add_f32 v50, v50, v114
    v_add_f32 v51, v51, v115
    v_add_f32 v52, v52, v116
    v_add_f32 v53, v53, v117
    v_add_f32 v54, v54, v118
    v_add_f32 v55, v55, v119
    v_add_f32 v56, v56, v120
    v_add_f32 v57, v57, v121
    v_add_f32 v58, v58, v122
    v_add_f32 v59, v59, v123
    v_add_f32 v60, v60, v124
    v_add_f32 v61, v61, v125
    v_add_f32 v62, v62, v126
    v_add_f32 v63, v63, v127
    s_add_u32 s16, s98, 8912896
    s_addc_u32 s17, s99, 0
    s_mov_b32 s18, 262144
    s_mov_b32 s19, 0x00020000
    s_mul_i32 s27, s26, 3072
    v_lshlrev_b32 v2, 4, v0
    v_add_u32 v2, s27, v2
    v_cvt_pk_bf16_f32 v64, v16, v17
    v_cvt_pk_bf16_f32 v65, v18, v19
    v_cvt_pk_bf16_f32 v66, v20, v21
    v_cvt_pk_bf16_f32 v67, v22, v23
    v_cvt_pk_bf16_f32 v68, v24, v25
    v_cvt_pk_bf16_f32 v69, v26, v27
    buffer_store_dwordx4 v[64:67], v2, s[16:19], 0 offen sc1
    v_cvt_pk_bf16_f32 v72, v32, v33
    v_cvt_pk_bf16_f32 v73, v34, v35
    v_cvt_pk_bf16_f32 v74, v36, v37
    v_cvt_pk_bf16_f32 v75, v38, v39
    v_cvt_pk_bf16_f32 v76, v40, v41
    v_cvt_pk_bf16_f32 v77, v42, v43
    v_cvt_pk_bf16_f32 v78, v44, v45
    v_cvt_pk_bf16_f32 v79, v46, v47
    v_and_b32 v1, 31, v0
    v_cmp_eq_u32 vcc, 20, v1
    v_mov_b32 v4, 0x3f803f80
    s_nop 1
    v_cndmask_b32 v72, v72, v4, vcc
    v_cndmask_b32 v73, v73, v4, vcc
    v_cndmask_b32 v74, v74, v4, vcc
    v_cndmask_b32 v75, v75, v4, vcc
    v_cndmask_b32 v76, v76, v4, vcc
    v_cndmask_b32 v77, v77, v4, vcc
    v_cndmask_b32 v78, v78, v4, vcc
    v_cndmask_b32 v79, v79, v4, vcc
    v_cmp_eq_u32 vcc, 21, v1
    s_nop 1
    v_cndmask_b32 v72, v72, 0, vcc
    v_cndmask_b32 v73, v73, 0, vcc
    v_cndmask_b32 v74, v74, 0, vcc
    v_cndmask_b32 v75, v75, 0, vcc
    v_cndmask_b32 v76, v76, 0, vcc
    v_cndmask_b32 v77, v77, 0, vcc
    v_cndmask_b32 v78, v78, 0, vcc
    v_cndmask_b32 v79, v79, 0, vcc
    v_mul_u32_u24 v3, 352, v9
    v_lshl_add_u32 v3, v1, 4, v3
    v_add_u32 v3, s27, v3
    v_mul_f32 v48, 0xbfb8aa3b, v48
    v_exp_f32 v48, v48
    s_nop 0
    v_add_f32 v48, 1.0, v48
    v_rcp_f32 v48, v48
    v_lshlrev_b32 v5, 3, v1
    v_add_u32 v5, s27, v5
    s_lshl_b32 s27, s26, 7
    v_lshlrev_b32 v6, 2, v1
    v_add_u32 v6, s27, v6
    v_cmp_ge_u32 vcc, 21, v1
    s_and_saveexec_b64 s[30:31], vcc
    buffer_store_dwordx4 v[72:75], v3, s[16:19], 0 offen offset:1280 sc1
    buffer_store_dwordx4 v[76:79], v3, s[16:19], 0 offen offset:1984 sc1
    s_mov_b64 exec, 0xffffffff
    buffer_store_dwordx2 v[68:69], v5, s[16:19], 0 offen offset:1024 sc1
    s_mov_b32 s27, 196608
    buffer_store_dword v48, v6, s[16:19], s27 offen sc1
    s_mov_b64 exec, -1
Lkv_end:
Lp_end:
    s_endpgm
.globl att_kernel
.p2align 8
.type att_kernel,@function
att_kernel:
    s_cmp_ge_u32 s2, 416
    s_cbranch_scc1 La_end
    s_load_dwordx2 s[98:99], s[0:1], 96
    s_load_dwordx16 s[64:79], s[0:1], 0
    s_load_dwordx8 s[80:87], s[0:1], 64
    v_lshrrev_b32 v1, 6, v0
    v_and_b32 v0, 63, v0
    s_nop 0
    v_readfirstlane_b32 s20, v1
    s_cmp_ge_u32 s2, 256
    s_cbranch_scc1 La_down
    s_and_b32 s23, s20, 3
    s_lshr_b32 s24, s20, 2
    s_mul_i32 s28, s20, 3072
    v_lshlrev_b32 v5, 4, v0
    v_add_u32 v5, s28, v5
    s_and_b32 s21, s2, 7
    s_lshl_b32 s21, s21, 3
    s_bfe_u32 s22, s2, 0x30003
    s_add_u32 s21, s21, s22
    s_lshl_b32 s21, s21, 5
    s_lshr_b32 s22, s2, 6
    s_mul_i32 s22, s22, 320
    s_mul_i32 s26, s21, 1280
    s_add_u32 s22, s22, s26
    s_lshl_b32 s26, s20, 6
    v_add_u32 v1, s26, v0
    v_mul_u32_u24 v6, 3277, v1
    v_lshrrev_b32 v6, 16, v6
    v_mul_u32_u24 v6, 960, v6
    v_lshl_add_u32 v125, v1, 4, v6
    v_add_u32 v125, s22, v125
    s_lshl_b32 s26, s20, 6
    v_add_u32 v1, s26, v0
    v_add_u32 v1, 512, v1
    v_mul_u32_u24 v6, 3277, v1
    v_lshrrev_b32 v6, 16, v6
    v_mul_u32_u24 v6, 960, v6
    v_lshl_add_u32 v126, v1, 4, v6
    v_add_u32 v126, s22, v126
    v_and_b32 v1, 31, v0
    v_lshrrev_b32 v7, 5, v0
    s_mul_i32 s26, s23, 80
    v_mul_u32_u24 v127, 320, v1
    v_add_u32 v127, s26, v127
    s_lshl_b32 s35, s20, 10
    s_waitcnt lgkmcnt(0)
    s_add_u32 s4, s98, 8912896
    s_addc_u32 s5, s99, 0
    s_mov_b32 s6, 196608
    s_mov_b32 s7, 0x00020000
    s_add_u32 s8, s98, 0
    s_addc_u32 s9, s99, 0
    s_mov_b32 s10, 2621440
    s_mov_b32 s11, 0x00020000
    s_mov_b32 s29, 0
    s_mov_b32 s30, 0
    s_add_u32 m0, s35, 49152
    s_nop 0
    buffer_load_dwordx4 v125, s[8:11], 0 offen lds
    s_cmp_ge_u32 s20, 2
    s_cbranch_scc1 La_q1
    s_add_u32 m0, s35, 57344
    s_nop 0
    buffer_load_dwordx4 v126, s[8:11], 0 offen lds
La_q1:
    s_add_u32 m0, s28, s30
    s_nop 0
    buffer_load_dwordx4 v5, s[4:7], s29 offen offset:0 lds
    buffer_load_dwordx4 v5, s[4:7], s29 offen offset:1024 lds
    buffer_load_dwordx4 v5, s[4:7], s29 offen offset:2048 lds
    s_add_u32 s29, s29, 24576
    s_add_u32 s30, s30, 24576
    s_cmp_eq_u32 s30, 73728
    s_cselect_b32 s30, 0, s30
    s_add_u32 m0, s28, s30
    s_nop 0
    buffer_load_dwordx4 v5, s[4:7], s29 offen offset:0 lds
    buffer_load_dwordx4 v5, s[4:7], s29 offen offset:1024 lds
    buffer_load_dwordx4 v5, s[4:7], s29 offen offset:2048 lds
    s_add_u32 s29, s29, 24576
    s_add_u32 s30, s30, 24576
    s_cmp_eq_u32 s30, 73728
    s_cselect_b32 s30, 0, s30
    s_add_u32 s12, s98, 9437184
    s_addc_u32 s13, s99, 0
    s_mov_b32 s14, 2621440
    s_mov_b32 s15, 0x00020000
    v_lshlrev_b32 v2, 4, v0
    v_lshlrev_b32 v3, 3, v1
    v_add_u32 v3, 1024, v3
    v_cmp_gt_u32 vcc, 32, v0
    v_mov_b32 v24, 1616
    s_nop 0
    v_cndmask_b32 v3, v24, v3, vcc
    v_bfe_u32 v4, v1, 2, 1
    v_lshlrev_b32 v4, 3, v4
    v_bfe_u32 v24, v1, 3, 1
    v_lshl_add_u32 v4, v24, 2, v4
    v_and_b32 v24, 3, v1
    v_add_u32 v4, v4, v24
    v_min_u32 v24, 21, v1
    v_cmp_gt_u32 vcc, 16, v1
    s_nop 1
    v_cndmask_b32 v4, v24, v4, vcc
    v_cmp_eq_u32 vcc, 24, v1
    v_mov_b32 v24, 20
    s_nop 0
    v_cndmask_b32 v4, v4, v24, vcc
    v_lshlrev_b32 v4, 4, v4
    v_mul_u32_u24 v24, 352, v7
    v_add_u32 v4, v4, v24
    v_add_u32 v4, 1280, v4
    s_mov_b32 s33, 0
    s_mov_b32 s34, 0x07060302
    s_mul_i32 s25, s24, 12288
    v_cmp_gt_u32 vcc, 32, v0
    v_mov_b32 v1, 0x3f803f80
    s_nop 0
    v_cndmask_b32 v30, 0, v1, vcc
    v_mov_b32 v14, 0
    v_mov_b32 v15, 0
    v_mov_b32 v22, 0
    v_mov_b32 v23, 0
    v_mov_b32 v31, 0
    s_cmp_eq_u32 s20, 0
    s_cbranch_scc0 La_w6
    s_waitcnt vmcnt(3)
La_w6:
    s_waitcnt vmcnt(6)
    s_barrier
    ds_read_b128 v[24:27], v2 offset:0
    ds_read_b64 v[28:29], v3 offset:0
    v_lshrrev_b32 v1, 5, v0
    v_lshl_add_u32 v6, v1, 4, v127
    ds_read_b64 v[8:9], v6 offset:49152
    ds_read_b64 v[10:11], v6 offset:49160
    ds_read_b64 v[12:13], v127 offset:49184
    ds_read_b64 v[16:17], v6 offset:49192
    ds_read_b64 v[18:19], v6 offset:49200
    ds_read_b64 v[20:21], v127 offset:49224
    v_cmp_gt_u32 vcc, 32, v0
    s_waitcnt lgkmcnt(0)
    v_cndmask_b32 v12, 0, v12, vcc
    v_cndmask_b32 v13, 0, v13, vcc
    v_cndmask_b32 v20, 0, v20, vcc
    v_cndmask_b32 v21, 0, v21, vcc
    s_nop 1
    v_mfma_f32_32x32x16_bf16 v[72:87], v[24:27], v[8:11], 0
    v_mfma_f32_32x32x16_bf16 v[72:87], v[28:31], v[12:15], v[72:87]
    v_mfma_f32_32x32x16_bf16 v[88:103], v[24:27], v[16:19], 0
    v_mfma_f32_32x32x16_bf16 v[88:103], v[28:31], v[20:23], v[88:103]
    s_nop 7
    s_nop 7
    v_max3_f32 v6, v72, v73, v74
    v_max_f32 v6, v6, v75
    v_max3_f32 v6, v6, v76, v77
    v_max3_f32 v6, v6, v78, v79
    v_max3_f32 v6, v6, v80, v81
    v_max3_f32 v6, v6, v82, v83
    v_max3_f32 v6, v6, v84, v85
    v_max3_f32 v6, v6, v86, v87
    v_mov_b32 v1, v6
    s_nop 1
    v_permlane32_swap_b32 v1, v6
    s_nop 1
    v_max_f32 v1, v1, v6
    v_sub_f32 v1, 0, v1
    v_mov_b32 v104, 0
    v_cvt_pk_bf16_f32 v104, v1, v104
    v_lshlrev_b32 v104, 16, v104
    v_sub_f32 v104, v1, v104
    v_cvt_pk_bf16_f32 v1, v1, v104
    v_cmp_gt_u32 vcc, 32, v0
    s_nop 1
    v_cndmask_b32 v14, 0, v1, vcc
    v_max3_f32 v7, v88, v89, v90
    v_max_f32 v7, v7, v91
    v_max3_f32 v7, v7, v92, v93
    v_max3_f32 v7, v7, v94, v95
    v_max3_f32 v7, v7, v96, v97
    v_max3_f32 v7, v7, v98, v99
    v_max3_f32 v7, v7, v100, v101
    v_max3_f32 v7, v7, v102, v103
    v_mov_b32 v1, v7
    s_nop 1
    v_permlane32_swap_b32 v1, v7
    s_nop 1
    v_max_f32 v1, v1, v7
    v_sub_f32 v1, 0, v1
    v_mov_b32 v104, 0
    v_cvt_pk_bf16_f32 v104, v1, v104
    v_lshlrev_b32 v104, 16, v104
    v_sub_f32 v104, v1, v104
    v_cvt_pk_bf16_f32 v1, v1, v104
    v_cmp_gt_u32 vcc, 32, v0
    s_nop 1
    v_cndmask_b32 v22, 0, v1, vcc
    s_waitcnt vmcnt(3)
    s_barrier
La_main:
    v_add_u32 v120, s25, v2
    v_add_u32 v121, s25, v3
    v_add_u32 v122, s25, v4
    ds_read_b128 v[24:27], v120 offset:0
    ds_read_b64 v[28:29], v121 offset:0
    v_mov_b32 v40, 0
    v_mov_b32 v41, 0
    v_mov_b32 v42, 0
    v_mov_b32 v43, 0
    v_mov_b32 v44, 0
    v_mov_b32 v45, 0
    v_mov_b32 v46, 0
    v_mov_b32 v47, 0
    v_mov_b32 v48, 0
    v_mov_b32 v49, 0
    v_mov_b32 v50, 0
    v_mov_b32 v51, 0
    v_mov_b32 v52, 0
    v_mov_b32 v53, 0
    v_mov_b32 v54, 0
    v_mov_b32 v55, 0
    v_mov_b32 v56, 0
    v_mov_b32 v57, 0
    v_mov_b32 v58, 0
    v_mov_b32 v59, 0
    v_mov_b32 v60, 0
    v_mov_b32 v61, 0
    v_mov_b32 v62, 0
    v_mov_b32 v63, 0
    v_mov_b32 v64, 0
    v_mov_b32 v65, 0
    v_mov_b32 v66, 0
    v_mov_b32 v67, 0
    v_mov_b32 v68, 0
    v_mov_b32 v69, 0
    v_mov_b32 v70, 0
    v_mov_b32 v71, 0
    v_mov_b32 v112, 0
    v_mov_b32 v113, 0
    v_mov_b32 v114, 0
    v_mov_b32 v115, 0
    v_mov_b32 v116, 0
    v_mov_b32 v117, 0
    v_mov_b32 v118, 0
    v_mov_b32 v119, 0
    v_mov_b32 v32, 0
    v_mov_b32 v33, 0
    v_mov_b32 v34, 0
    v_mov_b32 v35, 0
    v_mov_b32 v36, 0
    v_mov_b32 v37, 0
    v_mov_b32 v38, 0
    v_mov_b32 v39, 0
    s_waitcnt lgkmcnt(0)
    v_mfma_f32_32x32x16_bf16 v[72:87], v[24:27], v[8:11], 0
    v_mfma_f32_32x32x16_bf16 v[72:87], v[28:31], v[12:15], v[72:87]
    s_mov_b32 s32, 0
    s_mov_b32 s31, s25
    s_nop 7
    s_nop 3
La_loop:
    s_waitcnt vmcnt(0)
    s_barrier
    s_add_u32 s26, s31, 24576
    s_cmp_ge_u32 s26, 73728
    s_cselect_b32 s27, 73728, 0
    s_sub_u32 s26, s26, s27
    v_add_u32 v123, s26, v2
    v_add_u32 v124, s26, v3
    v_mfma_f32_32x32x16_bf16 v[88:103], v[24:27], v[16:19], 0
    s_add_u32 m0, s28, s30
    s_nop 0
    buffer_load_dwordx4 v5, s[4:7], s29 offen offset:0 lds
    v_exp_f32 v72, v72
    v_exp_f32 v73, v73
    v_exp_f32 v74, v74
    v_exp_f32 v75, v75
    v_mfma_f32_32x32x16_bf16 v[88:103], v[28:31], v[20:23], v[88:103]
    v_exp_f32 v76, v76
    v_exp_f32 v77, v77
    v_exp_f32 v78, v78
    v_exp_f32 v79, v79
    ds_read_b128 v[24:27], v120 offset:3072
    ds_read_b64 v[28:29], v121 offset:3072
    v_mfma_f32_32x32x16_bf16 v[56:71], v[32:35], v[112:115], v[56:71]
    v_cvt_pk_bf16_f32 v104, v72, v73
    v_cvt_pk_bf16_f32 v105, v74, v75
    v_cvt_pk_bf16_f32 v106, v76, v77
    v_cvt_pk_bf16_f32 v107, v78, v79
    v_exp_f32 v80, v80
    v_exp_f32 v81, v81
    v_exp_f32 v82, v82
    v_exp_f32 v83, v83
    v_mfma_f32_32x32x16_bf16 v[56:71], v[36:39], v[116:119], v[56:71]
    v_exp_f32 v84, v84
    v_exp_f32 v85, v85
    v_exp_f32 v86, v86
    v_exp_f32 v87, v87
    ds_read_b128 v[32:35], v122 offset:0
    ds_read_b128 v[36:39], v122 offset:704
    v_cvt_pk_bf16_f32 v108, v80, v81
    v_cvt_pk_bf16_f32 v109, v82, v83
    v_cvt_pk_bf16_f32 v110, v84, v85
    v_cvt_pk_bf16_f32 v111, v86, v87
    s_waitcnt lgkmcnt(2)
    v_mfma_f32_32x32x16_bf16 v[72:87], v[24:27], v[8:11], 0
    v_exp_f32 v88, v88
    v_exp_f32 v89, v89
    v_exp_f32 v90, v90
    v_exp_f32 v91, v91
    v_mfma_f32_32x32x16_bf16 v[72:87], v[28:31], v[12:15], v[72:87]
    v_exp_f32 v92, v92
    v_exp_f32 v93, v93
    v_exp_f32 v94, v94
    v_exp_f32 v95, v95
    s_waitcnt lgkmcnt(0)
    v_mfma_f32_32x32x16_bf16 v[40:55], v[32:35], v[104:107], v[40:55]
    v_cvt_pk_bf16_f32 v112, v88, v89
    v_cvt_pk_bf16_f32 v113, v90, v91
    v_cvt_pk_bf16_f32 v114, v92, v93
    v_cvt_pk_bf16_f32 v115, v94, v95
    v_exp_f32 v96, v96
    v_exp_f32 v97, v97
    v_exp_f32 v98, v98
    v_exp_f32 v99, v99
    v_mfma_f32_32x32x16_bf16 v[40:55], v[36:39], v[108:111], v[40:55]
    v_exp_f32 v100, v100
    v_exp_f32 v101, v101
    v_exp_f32 v102, v102
    v_exp_f32 v103, v103
    s_nop 0
    v_cvt_pk_bf16_f32 v116, v96, v97
    v_cvt_pk_bf16_f32 v117, v98, v99
    v_cvt_pk_bf16_f32 v118, v100, v101
    v_cvt_pk_bf16_f32 v119, v102, v103
    v_mfma_f32_32x32x16_bf16 v[88:103], v[24:27], v[16:19], 0
    buffer_load_dwordx4 v5, s[4:7], s29 offen offset:1024 lds
    v_exp_f32 v72, v72
    v_exp_f32 v73, v73
    v_exp_f32 v74, v74
    v_exp_f32 v75, v75
    v_mfma_f32_32x32x16_bf16 v[88:103], v[28:31], v[20:23], v[88:103]
    v_exp_f32 v76, v76
    v_exp_f32 v77, v77
    v_exp_f32 v78, v78
    v_exp_f32 v79, v79
    ds_read_b128 v[24:27], v120 offset:6144
    ds_read_b64 v[28:29], v121 offset:6144
    v_mfma_f32_32x32x16_bf16 v[56:71], v[32:35], v[112:115], v[56:71]
    v_cvt_pk_bf16_f32 v104, v72, v73
    v_cvt_pk_bf16_f32 v105, v74, v75
    v_cvt_pk_bf16_f32 v106, v76, v77
    v_cvt_pk_bf16_f32 v107, v78, v79
    v_exp_f32 v80, v80
    v_exp_f32 v81, v81
    v_exp_f32 v82, v82
    v_exp_f32 v83, v83
    v_mfma_f32_32x32x16_bf16 v[56:71], v[36:39], v[116:119], v[56:71]
    v_exp_f32 v84, v84
    v_exp_f32 v85, v85
    v_exp_f32 v86, v86
    v_exp_f32 v87, v87
    ds_read_b128 v[32:35], v122 offset:3072
    ds_read_b128 v[36:39], v122 offset:3776
    v_cvt_pk_bf16_f32 v108, v80, v81
    v_cvt_pk_bf16_f32 v109, v82, v83
    v_cvt_pk_bf16_f32 v110, v84, v85
    v_cvt_pk_bf16_f32 v111, v86, v87
    s_waitcnt lgkmcnt(2)
    v_mfma_f32_32x32x16_bf16 v[72:87], v[24:27], v[8:11], 0
    v_exp_f32 v88, v88
    v_exp_f32 v89, v89
    v_exp_f32 v90, v90
    v_exp_f32 v91, v91
    v_mfma_f32_32x32x16_bf16 v[72:87], v[28:31], v[12:15], v[72:87]
    v_exp_f32 v92, v92
    v_exp_f32 v93, v93
    v_exp_f32 v94, v94
    v_exp_f32 v95, v95
    s_waitcnt lgkmcnt(0)
    v_mfma_f32_32x32x16_bf16 v[40:55], v[32:35], v[104:107], v[40:55]
    v_cvt_pk_bf16_f32 v112, v88, v89
    v_cvt_pk_bf16_f32 v113, v90, v91
    v_cvt_pk_bf16_f32 v114, v92, v93
    v_cvt_pk_bf16_f32 v115, v94, v95
    v_exp_f32 v96, v96
    v_exp_f32 v97, v97
    v_exp_f32 v98, v98
    v_exp_f32 v99, v99
    v_mfma_f32_32x32x16_bf16 v[40:55], v[36:39], v[108:111], v[40:55]
    v_exp_f32 v100, v100
    v_exp_f32 v101, v101
    v_exp_f32 v102, v102
    v_exp_f32 v103, v103
    s_nop 0
    v_cvt_pk_bf16_f32 v116, v96, v97
    v_cvt_pk_bf16_f32 v117, v98, v99
    v_cvt_pk_bf16_f32 v118, v100, v101
    v_cvt_pk_bf16_f32 v119, v102, v103
    v_mfma_f32_32x32x16_bf16 v[88:103], v[24:27], v[16:19], 0
    buffer_load_dwordx4 v5, s[4:7], s29 offen offset:2048 lds
    s_add_u32 s29, s29, 24576
    s_add_u32 s30, s30, 24576
    s_cmp_eq_u32 s30, 73728
    s_cselect_b32 s30, 0, s30
    v_exp_f32 v72, v72
    v_exp_f32 v73, v73
    v_exp_f32 v74, v74
    v_exp_f32 v75, v75
    v_mfma_f32_32x32x16_bf16 v[88:103], v[28:31], v[20:23], v[88:103]
    v_exp_f32 v76, v76
    v_exp_f32 v77, v77
    v_exp_f32 v78, v78
    v_exp_f32 v79, v79
    ds_read_b128 v[24:27], v120 offset:9216
    ds_read_b64 v[28:29], v121 offset:9216
    v_mfma_f32_32x32x16_bf16 v[56:71], v[32:35], v[112:115], v[56:71]
    v_cvt_pk_bf16_f32 v104, v72, v73
    v_cvt_pk_bf16_f32 v105, v74, v75
    v_cvt_pk_bf16_f32 v106, v76, v77
    v_cvt_pk_bf16_f32 v107, v78, v79
    v_exp_f32 v80, v80
    v_exp_f32 v81, v81
    v_exp_f32 v82, v82
    v_exp_f32 v83, v83
    v_mfma_f32_32x32x16_bf16 v[56:71], v[36:39], v[116:119], v[56:71]
    v_exp_f32 v84, v84
    v_exp_f32 v85, v85
    v_exp_f32 v86, v86
    v_exp_f32 v87, v87
    ds_read_b128 v[32:35], v122 offset:6144
    ds_read_b128 v[36:39], v122 offset:6848
    v_cvt_pk_bf16_f32 v108, v80, v81
    v_cvt_pk_bf16_f32 v109, v82, v83
    v_cvt_pk_bf16_f32 v110, v84, v85
    v_cvt_pk_bf16_f32 v111, v86, v87
    s_waitcnt lgkmcnt(2)
    v_mfma_f32_32x32x16_bf16 v[72:87], v[24:27], v[8:11], 0
    v_exp_f32 v88, v88
    v_exp_f32 v89, v89
    v_exp_f32 v90, v90
    v_exp_f32 v91, v91
    v_mfma_f32_32x32x16_bf16 v[72:87], v[28:31], v[12:15], v[72:87]
    v_exp_f32 v92, v92
    v_exp_f32 v93, v93
    v_exp_f32 v94, v94
    v_exp_f32 v95, v95
    s_waitcnt lgkmcnt(0)
    v_mfma_f32_32x32x16_bf16 v[40:55], v[32:35], v[104:107], v[40:55]
    v_cvt_pk_bf16_f32 v112, v88, v89
    v_cvt_pk_bf16_f32 v113, v90, v91
    v_cvt_pk_bf16_f32 v114, v92, v93
    v_cvt_pk_bf16_f32 v115, v94, v95
    v_exp_f32 v96, v96
    v_exp_f32 v97, v97
    v_exp_f32 v98, v98
    v_exp_f32 v99, v99
    v_mfma_f32_32x32x16_bf16 v[40:55], v[36:39], v[108:111], v[40:55]
    v_exp_f32 v100, v100
    v_exp_f32 v101, v101
    v_exp_f32 v102, v102
    v_exp_f32 v103, v103
    s_nop 0
    v_cvt_pk_bf16_f32 v116, v96, v97
    v_cvt_pk_bf16_f32 v117, v98, v99
    v_cvt_pk_bf16_f32 v118, v100, v101
    v_cvt_pk_bf16_f32 v119, v102, v103
    v_mfma_f32_32x32x16_bf16 v[88:103], v[24:27], v[16:19], 0
    v_exp_f32 v72, v72
    v_exp_f32 v73, v73
    v_exp_f32 v74, v74
    v_exp_f32 v75, v75
    v_mfma_f32_32x32x16_bf16 v[88:103], v[28:31], v[20:23], v[88:103]
    v_exp_f32 v76, v76
    v_exp_f32 v77, v77
    v_exp_f32 v78, v78
    v_exp_f32 v79, v79
    ds_read_b128 v[24:27], v123 offset:0
    ds_read_b64 v[28:29], v124 offset:0
    v_mfma_f32_32x32x16_bf16 v[56:71], v[32:35], v[112:115], v[56:71]
    v_cvt_pk_bf16_f32 v104, v72, v73
    v_cvt_pk_bf16_f32 v105, v74, v75
    v_cvt_pk_bf16_f32 v106, v76, v77
    v_cvt_pk_bf16_f32 v107, v78, v79
    v_exp_f32 v80, v80
    v_exp_f32 v81, v81
    v_exp_f32 v82, v82
    v_exp_f32 v83, v83
    v_mfma_f32_32x32x16_bf16 v[56:71], v[36:39], v[116:119], v[56:71]
    v_exp_f32 v84, v84
    v_exp_f32 v85, v85
    v_exp_f32 v86, v86
    v_exp_f32 v87, v87
    ds_read_b128 v[32:35], v122 offset:9216
    ds_read_b128 v[36:39], v122 offset:9920
    v_cvt_pk_bf16_f32 v108, v80, v81
    v_cvt_pk_bf16_f32 v109, v82, v83
    v_cvt_pk_bf16_f32 v110, v84, v85
    v_cvt_pk_bf16_f32 v111, v86, v87
    s_waitcnt lgkmcnt(2)
    v_mfma_f32_32x32x16_bf16 v[72:87], v[24:27], v[8:11], 0
    v_exp_f32 v88, v88
    v_exp_f32 v89, v89
    v_exp_f32 v90, v90
    v_exp_f32 v91, v91
    v_mfma_f32_32x32x16_bf16 v[72:87], v[28:31], v[12:15], v[72:87]
    v_exp_f32 v92, v92
    v_exp_f32 v93, v93
    v_exp_f32 v94, v94
    v_exp_f32 v95, v95
    s_waitcnt lgkmcnt(0)
    v_mfma_f32_32x32x16_bf16 v[40:55], v[32:35], v[104:107], v[40:55]
    v_cvt_pk_bf16_f32 v112, v88, v89
    v_cvt_pk_bf16_f32 v113, v90, v91
    v_cvt_pk_bf16_f32 v114, v92, v93
    v_cvt_pk_bf16_f32 v115, v94, v95
    v_exp_f32 v96, v96
    v_exp_f32 v97, v97
    v_exp_f32 v98, v98
    v_exp_f32 v99, v99
    v_mfma_f32_32x32x16_bf16 v[40:55], v[36:39], v[108:111], v[40:55]
    v_exp_f32 v100, v100
    v_exp_f32 v101, v101
    v_exp_f32 v102, v102
    v_exp_f32 v103, v103
    s_nop 0
    v_cvt_pk_bf16_f32 v116, v96, v97
    v_cvt_pk_bf16_f32 v117, v98, v99
    v_cvt_pk_bf16_f32 v118, v100, v101
    v_cvt_pk_bf16_f32 v119, v102, v103
    s_mov_b32 s31, s26
    v_mov_b32 v120, v123
    v_mov_b32 v121, v124
    v_add_u32 v122, s26, v4
    s_add_u32 s32, s32, 1
    s_cmp_lt_u32 s32, 8
    s_cbranch_scc1 La_loop
    v_mfma_f32_32x32x16_bf16 v[56:71], v[32:35], v[112:115], v[56:71]
    v_mfma_f32_32x32x16_bf16 v[56:71], v[36:39], v[116:119], v[56:71]
    s_waitcnt vmcnt(0) lgkmcnt(0)
    s_barrier
    s_nop 7
    s_nop 7
    s_lshl_b32 s26, s23, 13
    v_lshlrev_b32 v1, 4, v0
    v_add_u32 v1, s26, v1
    v_cmp_gt_u32 vcc, 32, v0
    s_nop 1
    v_cndmask_b32 v6, v48, v52, vcc
    v_cndmask_b32 v7, v64, v68, vcc
    v_max_f32 v104, v6, v7
    v_add_f32 v72, v6, v7
    v_add_f32 v104, v104, v72
    s_mov_b32 s26, 0x71000000
    v_cmp_gt_f32 vcc, s26, v104
    s_cmp_eq_u64 vcc, exec
    s_cselect_b32 s26, 0, 1
    v_mov_b32 v72, s26
    s_lshl_b32 s27, s20, 2
    v_mov_b32 v73, s27
    ds_write_b32 v73, v72 offset:40960
    s_cmp_eq_u32 s24, 0
    s_cbranch_scc1 La_c0
    ds_write_b128 v1, v[40:43] offset:0
    ds_write_b128 v1, v[44:47] offset:1024
    ds_write_b128 v1, v[48:51] offset:2048
    ds_write_b128 v1, v[52:55] offset:3072
    ds_write_b128 v1, v[56:59] offset:4096
    ds_write_b128 v1, v[60:63] offset:5120
    ds_write_b128 v1, v[64:67] offset:6144
    ds_write_b128 v1, v[68:71] offset:7168
La_c0:
    s_waitcnt lgkmcnt(0)
    s_barrier
    v_mov_b32 v104, 0
    ds_read_b128 v[108:111], v104 offset:40960
    ds_read_b128 v[112:115], v104 offset:40976
    ds_read_b128 v[72:75], v1 offset:0
    ds_read_b128 v[76:79], v1 offset:1024
    ds_read_b128 v[80:83], v1 offset:2048
    ds_read_b128 v[84:87], v1 offset:3072
    ds_read_b128 v[88:91], v1 offset:4096
    ds_read_b128 v[92:95], v1 offset:5120
    ds_read_b128 v[96:99], v1 offset:6144
    ds_read_b128 v[100:103], v1 offset:7168
    s_waitcnt lgkmcnt(0)
    v_add_f32 v40, v40, v72
    v_add_f32 v41, v41, v73
    v_add_f32 v42, v42, v74
    v_add_f32 v43, v43, v75
    v_add_f32 v44, v44, v76
    v_add_f32 v45, v45, v77
    v_add_f32 v46, v46, v78
    v_add_f32 v47, v47, v79
    v_add_f32 v48, v48, v80
    v_add_f32 v49, v49, v81
    v_add_f32 v50, v50, v82
    v_add_f32 v51, v51, v83
    v_add_f32 v52, v52, v84
    v_add_f32 v53, v53, v85
    v_add_f32 v54, v54, v86
    v_add_f32 v55, v55, v87
    v_add_f32 v56, v56, v88
    v_add_f32 v57, v57, v89
    v_add_f32 v58, v58, v90
    v_add_f32 v59, v59, v91
    v_add_f32 v60, v60, v92
    v_add_f32 v61, v61, v93
    v_add_f32 v62, v62, v94
    v_add_f32 v63, v63, v95
    v_add_f32 v64, v64, v96
    v_add_f32 v65, v65, v97
    v_add_f32 v66, v66, v98
    v_add_f32 v67, v67, v99
    v_add_f32 v68, v68, v100
    v_add_f32 v69, v69, v101
    v_add_f32 v70, v70, v102
    v_add_f32 v71, v71, v103
    v_cmp_gt_u32 vcc, 32, v0
    s_nop 1
    v_cndmask_b32 v6, v48, v52, vcc
    v_cndmask_b32 v7, v64, v68, vcc
    v_or3_b32 v76, v108, v109, v110
    v_or3_b32 v77, v111, v112, v113
    v_or_b32 v78, v114, v115
    v_mov_b32 v79, 0
    v_or3_b32 v76, v76, v77, v78
    v_or_b32 v76, v76, v79
    s_nop 0
    v_readfirstlane_b32 s26, v76
    s_nop 3
    s_andn2_b32 s26, s26, s33
    s_cmp_eq_u32 s26, 0
    s_cbranch_scc1 La_fin
    s_mov_b32 s33, 1
    s_barrier
    s_mov_b32 s29, 0
    s_mov_b32 s30, 0
    s_add_u32 m0, s28, s30
    s_nop 0
    buffer_load_dwordx4 v5, s[4:7], s29 offen offset:0 lds
    buffer_load_dwordx4 v5, s[4:7], s29 offen offset:1024 lds
    buffer_load_dwordx4 v5, s[4:7], s29 offen offset:2048 lds
    s_add_u32 s29, s29, 24576
    s_add_u32 s30, s30, 24576
    s_cmp_eq_u32 s30, 73728
    s_cselect_b32 s30, 0, s30
    s_add_u32 m0, s28, s30
    s_nop 0
    buffer_load_dwordx4 v5, s[4:7], s29 offen offset:0 lds
    buffer_load_dwordx4 v5, s[4:7], s29 offen offset:1024 lds
    buffer_load_dwordx4 v5, s[4:7], s29 offen offset:2048 lds
    s_add_u32 s29, s29, 24576
    s_add_u32 s30, s30, 24576
    s_cmp_eq_u32 s30, 73728
    s_cselect_b32 s30, 0, s30
    s_waitcnt vmcnt(3)
    s_barrier
    v_mov_b32 v6, 0xff800000
    v_mov_b32 v7, 0xff800000
    v_mov_b32 v14, 0
    v_mov_b32 v22, 0
    s_mov_b32 s32, 0
    s_mov_b32 s31, 0
La_maxloop:
    s_waitcnt vmcnt(0)
    s_barrier
    s_add_u32 m0, s28, s30
    s_nop 0
    buffer_load_dwordx4 v5, s[4:7], s29 offen offset:0 lds
    buffer_load_dwordx4 v5, s[4:7], s29 offen offset:1024 lds
    buffer_load_dwordx4 v5, s[4:7], s29 offen offset:2048 lds
    s_add_u32 s29, s29, 24576
    s_add_u32 s30, s30, 24576
    s_cmp_eq_u32 s30, 73728
    s_cselect_b32 s30, 0, s30
    v_add_u32 v120, s31, v2
    v_add_u32 v121, s31, v3
    ds_read_b128 v[24:27], v120 offset:0
    ds_read_b64 v[28:29], v121 offset:0
    s_waitcnt lgkmcnt(0)
    v_mfma_f32_32x32x16_bf16 v[72:87], v[24:27], v[8:11], 0
    v_mfma_f32_32x32x16_bf16 v[72:87], v[28:31], v[12:15], v[72:87]
    v_mfma_f32_32x32x16_bf16 v[88:103], v[24:27], v[16:19], 0
    v_mfma_f32_32x32x16_bf16 v[88:103], v[28:31], v[20:23], v[88:103]
    s_nop 7
    s_nop 7
    v_max3_f32 v6, v6, v72, v73
    v_max3_f32 v6, v6, v74, v75
    v_max3_f32 v6, v6, v76, v77
    v_max3_f32 v6, v6, v78, v79
    v_max3_f32 v6, v6, v80, v81
    v_max3_f32 v6, v6, v82, v83
    v_max3_f32 v6, v6, v84, v85
    v_max3_f32 v6, v6, v86, v87
    v_max3_f32 v7, v7, v88, v89
    v_max3_f32 v7, v7, v90, v91
    v_max3_f32 v7, v7, v92, v93
    v_max3_f32 v7, v7, v94, v95
    v_max3_f32 v7, v7, v96, v97
    v_max3_f32 v7, v7, v98, v99
    v_max3_f32 v7, v7, v100, v101
    v_max3_f32 v7, v7, v102, v103
    ds_read_b128 v[24:27], v120 offset:3072
    ds_read_b64 v[28:29], v121 offset:3072
    s_waitcnt lgkmcnt(0)
    v_mfma_f32_32x32x16_bf16 v[72:87], v[24:27], v[8:11], 0
    v_mfma_f32_32x32x16_bf16 v[72:87], v[28:31], v[12:15], v[72:87]
    v_mfma_f32_32x32x16_bf16 v[88:103], v[24:27], v[16:19], 0
    v_mfma_f32_32x32x16_bf16 v[88:103], v[28:31], v[20:23], v[88:103]
    s_nop 7
    s_nop 7
    v_max3_f32 v6, v6, v72, v73
    v_max3_f32 v6, v6, v74, v75
    v_max3_f32 v6, v6, v76, v77
    v_max3_f32 v6, v6, v78, v79
    v_max3_f32 v6, v6, v80, v81
    v_max3_f32 v6, v6, v82, v83
    v_max3_f32 v6, v6, v84, v85
    v_max3_f32 v6, v6, v86, v87
    v_max3_f32 v7, v7, v88, v89
    v_max3_f32 v7, v7, v90, v91
    v_max3_f32 v7, v7, v92, v93
    v_max3_f32 v7, v7, v94, v95
    v_max3_f32 v7, v7, v96, v97
    v_max3_f32 v7, v7, v98, v99
    v_max3_f32 v7, v7, v100, v101
    v_max3_f32 v7, v7, v102, v103
    ds_read_b128 v[24:27], v120 offset:6144
    ds_read_b64 v[28:29], v121 offset:6144
    s_waitcnt lgkmcnt(0)
    v_mfma_f32_32x32x16_bf16 v[72:87], v[24:27], v[8:11], 0
    v_mfma_f32_32x32x16_bf16 v[72:87], v[28:31], v[12:15], v[72:87]
    v_mfma_f32_32x32x16_bf16 v[88:103], v[24:27], v[16:19], 0
    v_mfma_f32_32x32x16_bf16 v[88:103], v[28:31], v[20:23], v[88:103]
    s_nop 7
    s_nop 7
    v_max3_f32 v6, v6, v72, v73
    v_max3_f32 v6, v6, v74, v75
    v_max3_f32 v6, v6, v76, v77
    v_max3_f32 v6, v6, v78, v79
    v_max3_f32 v6, v6, v80, v81
    v_max3_f32 v6, v6, v82, v83
    v_max3_f32 v6, v6, v84, v85
    v_max3_f32 v6, v6, v86, v87
    v_max3_f32 v7, v7, v88, v89
    v_max3_f32 v7, v7, v90, v91
    v_max3_f32 v7, v7, v92, v93
    v_max3_f32 v7, v7, v94, v95
    v_max3_f32 v7, v7, v96, v97
    v_max3_f32 v7, v7, v98, v99
    v_max3_f32 v7, v7, v100, v101
    v_max3_f32 v7, v7, v102, v103
    ds_read_b128 v[24:27], v120 offset:9216
    ds_read_b64 v[28:29], v121 offset:9216
    s_waitcnt lgkmcnt(0)
    v_mfma_f32_32x32x16_bf16 v[72:87], v[24:27], v[8:11], 0
    v_mfma_f32_32x32x16_bf16 v[72:87], v[28:31], v[12:15], v[72:87]
    v_mfma_f32_32x32x16_bf16 v[88:103], v[24:27], v[16:19], 0
    v_mfma_f32_32x32x16_bf16 v[88:103], v[28:31], v[20:23], v[88:103]
    s_nop 7
    s_nop 7
    v_max3_f32 v6, v6, v72, v73
    v_max3_f32 v6, v6, v74, v75
    v_max3_f32 v6, v6, v76, v77
    v_max3_f32 v6, v6, v78, v79
    v_max3_f32 v6, v6, v80, v81
    v_max3_f32 v6, v6, v82, v83
    v_max3_f32 v6, v6, v84, v85
    v_max3_f32 v6, v6, v86, v87
    v_max3_f32 v7, v7, v88, v89
    v_max3_f32 v7, v7, v90, v91
    v_max3_f32 v7, v7, v92, v93
    v_max3_f32 v7, v7, v94, v95
    v_max3_f32 v7, v7, v96, v97
    v_max3_f32 v7, v7, v98, v99
    v_max3_f32 v7, v7, v100, v101
    v_max3_f32 v7, v7, v102, v103
    ds_read_b128 v[24:27], v120 offset:12288
    ds_read_b64 v[28:29], v121 offset:12288
    s_waitcnt lgkmcnt(0)
    v_mfma_f32_32x32x16_bf16 v[72:87], v[24:27], v[8:11], 0
    v_mfma_f32_32x32x16_bf16 v[72:87], v[28:31], v[12:15], v[72:87]
    v_mfma_f32_32x32x16_bf16 v[88:103], v[24:27], v[16:19], 0
    v_mfma_f32_32x32x16_bf16 v[88:103], v[28:31], v[20:23], v[88:103]
    s_nop 7
    s_nop 7
    v_max3_f32 v6, v6, v72, v73
    v_max3_f32 v6, v6, v74, v75
    v_max3_f32 v6, v6, v76, v77
    v_max3_f32 v6, v6, v78, v79
    v_max3_f32 v6, v6, v80, v81
    v_max3_f32 v6, v6, v82, v83
    v_max3_f32 v6, v6, v84, v85
    v_max3_f32 v6, v6, v86, v87
    v_max3_f32 v7, v7, v88, v89
    v_max3_f32 v7, v7, v90, v91
    v_max3_f32 v7, v7, v92, v93
    v_max3_f32 v7, v7, v94, v95
    v_max3_f32 v7, v7, v96, v97
    v_max3_f32 v7, v7, v98, v99
    v_max3_f32 v7, v7, v100, v101
    v_max3_f32 v7, v7, v102, v103
    ds_read_b128 v[24:27], v120 offset:15360
    ds_read_b64 v[28:29], v121 offset:15360
    s_waitcnt lgkmcnt(0)
    v_mfma_f32_32x32x16_bf16 v[72:87], v[24:27], v[8:11], 0
    v_mfma_f32_32x32x16_bf16 v[72:87], v[28:31], v[12:15], v[72:87]
    v_mfma_f32_32x32x16_bf16 v[88:103], v[24:27], v[16:19], 0
    v_mfma_f32_32x32x16_bf16 v[88:103], v[28:31], v[20:23], v[88:103]
    s_nop 7
    s_nop 7
    v_max3_f32 v6, v6, v72, v73
    v_max3_f32 v6, v6, v74, v75
    v_max3_f32 v6, v6, v76, v77
    v_max3_f32 v6, v6, v78, v79
    v_max3_f32 v6, v6, v80, v81
    v_max3_f32 v6, v6, v82, v83
    v_max3_f32 v6, v6, v84, v85
    v_max3_f32 v6, v6, v86, v87
    v_max3_f32 v7, v7, v88, v89
    v_max3_f32 v7, v7, v90, v91
    v_max3_f32 v7, v7, v92, v93
    v_max3_f32 v7, v7, v94, v95
    v_max3_f32 v7, v7, v96, v97
    v_max3_f32 v7, v7, v98, v99
    v_max3_f32 v7, v7, v100, v101
    v_max3_f32 v7, v7, v102, v103
    ds_read_b128 v[24:27], v120 offset:18432
    ds_read_b64 v[28:29], v121 offset:18432
    s_waitcnt lgkmcnt(0)
    v_mfma_f32_32x32x16_bf16 v[72:87], v[24:27], v[8:11], 0
    v_mfma_f32_32x32x16_bf16 v[72:87], v[28:31], v[12:15], v[72:87]
    v_mfma_f32_32x32x16_bf16 v[88:103], v[24:27], v[16:19], 0
    v_mfma_f32_32x32x16_bf16 v[88:103], v[28:31], v[20:23], v[88:103]
    s_nop 7
    s_nop 7
    v_max3_f32 v6, v6, v72, v73
    v_max3_f32 v6, v6, v74, v75
    v_max3_f32 v6, v6, v76, v77
    v_max3_f32 v6, v6, v78, v79
    v_max3_f32 v6, v6, v80, v81
    v_max3_f32 v6, v6, v82, v83
    v_max3_f32 v6, v6, v84, v85
    v_max3_f32 v6, v6, v86, v87
    v_max3_f32 v7, v7, v88, v89
    v_max3_f32 v7, v7, v90, v91
    v_max3_f32 v7, v7, v92, v93
    v_max3_f32 v7, v7, v94, v95
    v_max3_f32 v7, v7, v96, v97
    v_max3_f32 v7, v7, v98, v99
    v_max3_f32 v7, v7, v100, v101
    v_max3_f32 v7, v7, v102, v103
    ds_read_b128 v[24:27], v120 offset:21504
    ds_read_b64 v[28:29], v121 offset:21504
    s_waitcnt lgkmcnt(0)
    v_mfma_f32_32x32x16_bf16 v[72:87], v[24:27], v[8:11], 0
    v_mfma_f32_32x32x16_bf16 v[72:87], v[28:31], v[12:15], v[72:87]
    v_mfma_f32_32x32x16_bf16 v[88:103], v[24:27], v[16:19], 0
    v_mfma_f32_32x32x16_bf16 v[88:103], v[28:31], v[20:23], v[88:103]
    s_nop 7
    s_nop 7
    v_max3_f32 v6, v6, v72, v73
    v_max3_f32 v6, v6, v74, v75
    v_max3_f32 v6, v6, v76, v77
    v_max3_f32 v6, v6, v78, v79
    v_max3_f32 v6, v6, v80, v81
    v_max3_f32 v6, v6, v82, v83
    v_max3_f32 v6, v6, v84, v85
    v_max3_f32 v6, v6, v86, v87
    v_max3_f32 v7, v7, v88, v89
    v_max3_f32 v7, v7, v90, v91
    v_max3_f32 v7, v7, v92, v93
    v_max3_f32 v7, v7, v94, v95
    v_max3_f32 v7, v7, v96, v97
    v_max3_f32 v7, v7, v98, v99
    v_max3_f32 v7, v7, v100, v101
    v_max3_f32 v7, v7, v102, v103
    s_add_u32 s31, s31, 24576
    s_cmp_eq_u32 s31, 73728
    s_cselect_b32 s31, 0, s31
    s_add_u32 s32, s32, 1
    s_cmp_lt_u32 s32, 8
    s_cbranch_scc1 La_maxloop
    v_mov_b32 v1, v6
    s_nop 1
    v_permlane32_swap_b32 v1, v6
    s_nop 1
    v_max_f32 v1, v1, v6
    v_sub_f32 v1, 0, v1
    v_mov_b32 v104, 0
    v_cvt_pk_bf16_f32 v104, v1, v104
    v_lshlrev_b32 v104, 16, v104
    v_sub_f32 v104, v1, v104
    v_cvt_pk_bf16_f32 v1, v1, v104
    v_cmp_gt_u32 vcc, 32, v0
    s_nop 1
    v_cndmask_b32 v14, 0, v1, vcc
    v_mov_b32 v1, v7
    s_nop 1
    v_permlane32_swap_b32 v1, v7
    s_nop 1
    v_max_f32 v1, v1, v7
    v_sub_f32 v1, 0, v1
    v_mov_b32 v104, 0
    v_cvt_pk_bf16_f32 v104, v1, v104
    v_lshlrev_b32 v104, 16, v104
    v_sub_f32 v104, v1, v104
    v_cvt_pk_bf16_f32 v1, v1, v104
    v_cmp_gt_u32 vcc, 32, v0
    s_nop 1
    v_cndmask_b32 v22, 0, v1, vcc
    s_waitcnt vmcnt(0)
    s_barrier
    s_mov_b32 s29, 0
    s_mov_b32 s30, 0
    s_add_u32 m0, s28, s30
    s_nop 0
    buffer_load_dwordx4 v5, s[4:7], s29 offen offset:0 lds
    buffer_load_dwordx4 v5, s[4:7], s29 offen offset:1024 lds
    buffer_load_dwordx4 v5, s[4:7], s29 offen offset:2048 lds
    s_add_u32 s29, s29, 24576
    s_add_u32 s30, s30, 24576
    s_cmp_eq_u32 s30, 73728
    s_cselect_b32 s30, 0, s30
    s_add_u32 m0, s28, s30
    s_nop 0
    buffer_load_dwordx4 v5, s[4:7], s29 offen offset:0 lds
    buffer_load_dwordx4 v5, s[4:7], s29 offen offset:1024 lds
    buffer_load_dwordx4 v5, s[4:7], s29 offen offset:2048 lds
    s_add_u32 s29, s29, 24576
    s_add_u32 s30, s30, 24576
    s_cmp_eq_u32 s30, 73728
    s_cselect_b32 s30, 0, s30
    s_waitcnt vmcnt(3)
    s_barrier
    s_branch La_main
La_fin:
    s_cmp_eq_u32 s24, 0
    s_cbranch_scc0 La_done
    v_rcp_f32 v6, v6
    v_rcp_f32 v7, v7
    v_lshrrev_b32 v1, 5, v0
    v_lshl_add_u32 v2, v1, 4, v127
    v_mul_f32 v40, v40, v6
    v_mul_f32 v41, v41, v6
    v_mul_f32 v42, v42, v6
    v_mul_f32 v43, v43, v6
    v_mul_f32 v44, v44, v6
    v_mul_f32 v45, v45, v6
    v_mul_f32 v46, v46, v6
    v_mul_f32 v47, v47, v6
    v_mul_f32 v48, v48, v6
    v_mul_f32 v49, v49, v6
    v_mul_f32 v50, v50, v6
    v_mul_f32 v51, v51, v6
    v_cvt_pk_bf16_f32 v72, v40, v41
    v_cvt_pk_bf16_f32 v73, v42, v43
    v_cvt_pk_bf16_f32 v74, v44, v45
    v_cvt_pk_bf16_f32 v75, v46, v47
    v_cvt_pk_bf16_f32 v76, v48, v49
    v_cvt_pk_bf16_f32 v77, v50, v51
    ds_write_b64 v2, v[72:73] offset:49152
    ds_write_b64 v2, v[74:75] offset:49160
    v_mul_f32 v56, v56, v7
    v_mul_f32 v57, v57, v7
    v_mul_f32 v58, v58, v7
    v_mul_f32 v59, v59, v7
    v_mul_f32 v60, v60, v7
    v_mul_f32 v61, v61, v7
    v_mul_f32 v62, v62, v7
    v_mul_f32 v63, v63, v7
    v_mul_f32 v64, v64, v7
    v_mul_f32 v65, v65, v7
    v_mul_f32 v66, v66, v7
    v_mul_f32 v67, v67, v7
    v_cvt_pk_bf16_f32 v80, v56, v57
    v_cvt_pk_bf16_f32 v81, v58, v59
    v_cvt_pk_bf16_f32 v82, v60, v61
    v_cvt_pk_bf16_f32 v83, v62, v63
    v_cvt_pk_bf16_f32 v84, v64, v65
    v_cvt_pk_bf16_f32 v85, v66, v67
    ds_write_b64 v2, v[80:81] offset:49192
    ds_write_b64 v2, v[82:83] offset:49200
    s_mov_b64 exec, 0xffffffff
    ds_write_b64 v127, v[76:77] offset:49184
    ds_write_b64 v127, v[84:85] offset:49224
    s_mov_b64 exec, -1
    s_waitcnt lgkmcnt(0)
La_done:
    s_barrier
    v_lshlrev_b32 v1, 4, v0
    v_add_u32 v1, s35, v1
    ds_read_b128 v[72:75], v1 offset:49152
    ds_read_b128 v[76:79], v1 offset:57344
    s_waitcnt lgkmcnt(1)
    buffer_store_dwordx4 v[72:75], v125, s[12:15], 0 offen sc1
    s_cmp_ge_u32 s20, 2
    s_cbranch_scc1 La_q2
    s_waitcnt lgkmcnt(0)
    buffer_store_dwordx4 v[76:79], v126, s[12:15], 0 offen sc1
La_q2:
    s_endpgm
La_down:
    s_cmp_ge_u32 s20, 4
    s_cbranch_scc1 La_end
    s_sub_u32 s3, s2, 256
    s_and_b32 s26, s3, 7
    s_lshl_b32 s26, s26, 1
    s_bfe_u32 s27, s3, 0x10003
    s_add_u32 s26, s26, s27
    s_lshl_b32 s21, s26, 7
    s_lshr_b32 s26, s3, 4
    s_mul_i32 s31, s26, 13
    s_lshr_b32 s31, s31, 6
    s_mul_i32 s27, s31, 5
    s_sub_u32 s26, s26, s27
    s_lshl_b32 s22, s26, 8
    s_add_u32 s23, s22, 128
    s_mul_i32 s24, s31, 768
    s_mul_i32 s35, s26, 3
    s_bfe_u32 s27, s3, 0x10003
    s_lshl_b32 s27, s27, 2
    s_add_u32 s35, s35, s27
    s_and_b32 s35, s35, 7
    s_cmp_ge_u32 s20, 2
    s_cselect_b32 s25, s23, s22
    s_lshl_b32 s26, s20, 5
    s_add_u32 s26, s26, s21
    v_lshrrev_b32 v1, 3, v0
    v_add_u32 v1, s26, v1
    s_mov_b32 s27, 3072
    v_mul_lo_u32 v2, v1, s27
    s_lshl_b32 s26, s24, 1
    v_add_u32 v2, s26, v2
    v_lshrrev_b32 v1, 4, v0
    v_xor_b32 v1, v1, v0
    v_and_b32 v1, 7, v1
    v_xor_b32 v9, 4, v1
    v_add_u32 v3, 24576, v2
    v_lshl_add_u32 v2, v1, 4, v2
    v_lshl_add_u32 v3, v9, 4, v3
    v_add_u32 v4, 49152, v2
    v_add_u32 v5, 49152, v3
    s_and_b32 s26, s20, 1
    s_mul_i32 s26, s26, 32
    s_add_u32 s26, s26, s24
    v_lshrrev_b32 v1, 3, v0
    v_add_u32 v1, s26, v1
    s_mov_b32 s27, 1280
    v_mul_lo_u32 v10, v1, s27
    v_lshrrev_b32 v1, 2, v0
    v_and_b32 v1, 4, v1
    v_xor_b32 v1, v1, v0
    v_and_b32 v1, 7, v1
    v_lshl_add_u32 v10, v1, 4, v10
    v_add_u32 v10, s25, v10
    v_add_u32 v11, 10240, v10
    v_add_u32 v12, 20480, v10
    v_add_u32 v13, 30720, v10
    s_lshl_b32 s28, s20, 12
    s_mul_i32 s38, s20, 4096
    s_lshl_b32 s29, s35, 7
    s_mul_i32 s30, s35, 81920
    s_waitcnt lgkmcnt(0)
    s_add_u32 s4, s98, 2621440
    s_addc_u32 s5, s99, 0
    s_mov_b32 s6, 6291456
    s_mov_b32 s7, 0x00020000
    s_mov_b32 s8, s80
    s_mov_b32 s9, s81
    s_mov_b32 s10, 1966080
    s_mov_b32 s11, 0x00020000
    s_mov_b32 s12, s80
    s_mov_b32 s13, s81
    s_mov_b32 s14, 1966080
    s_mov_b32 s15, 0x00020000
    s_cmp_ge_u32 s20, 2
    s_cselect_b32 s8, s12, s8
    s_cselect_b32 s9, s13, s9
    s_cselect_b32 s10, s14, s10
    s_add_u32 m0, s28, 0
    s_nop 0
    buffer_load_dwordx4 v2, s[4:7], s29 offen lds
    s_add_u32 m0, s28, 1024
    s_nop 0
    buffer_load_dwordx4 v3, s[4:7], s29 offen lds
    s_add_u32 m0, s28, 2048
    s_nop 0
    buffer_load_dwordx4 v4, s[4:7], s29 offen lds
    s_add_u32 m0, s28, 3072
    s_nop 0
    buffer_load_dwordx4 v5, s[4:7], s29 offen lds
    s_add_u32 s29, s29, 128
    s_cmp_eq_u32 s29, 1536
    s_cselect_b32 s29, 0, s29
    s_add_u32 m0, s38, 49152
    s_nop 0
    buffer_load_dwordx4 v10, s[8:11], s30 offen lds
    s_add_u32 m0, s38, 50176
    s_nop 0
    buffer_load_dwordx4 v11, s[8:11], s30 offen lds
    s_add_u32 m0, s38, 51200
    s_nop 0
    buffer_load_dwordx4 v12, s[8:11], s30 offen lds
    s_add_u32 m0, s38, 52224
    s_nop 0
    buffer_load_dwordx4 v13, s[8:11], s30 offen lds
    s_add_u32 s30, s30, 81920
    s_cmp_eq_u32 s30, 983040
    s_cselect_b32 s30, 0, s30
    s_add_u32 m0, s28, 16384
    s_nop 0
    buffer_load_dwordx4 v2, s[4:7], s29 offen lds
    s_add_u32 m0, s28, 17408
    s_nop 0
    buffer_load_dwordx4 v3, s[4:7], s29 offen lds
    s_add_u32 m0, s28, 18432
    s_nop 0
    buffer_load_dwordx4 v4, s[4:7], s29 offen lds
    s_add_u32 m0, s28, 19456
    s_nop 0
    buffer_load_dwordx4 v5, s[4:7], s29 offen lds
    s_add_u32 s29, s29, 128
    s_cmp_eq_u32 s29, 1536
    s_cselect_b32 s29, 0, s29
    s_and_b32 s26, s20, 1
    s_lshl_b32 s26, s26, 6
    v_and_b32 v1, 31, v0
    v_add_u32 v1, s26, v1
    v_lshlrev_b32 v6, 7, v1
    v_lshrrev_b32 v1, 5, v0
    v_bfe_u32 v9, v0, 1, 3
    v_xor_b32 v1, v1, v9
    v_lshl_add_u32 v6, v1, 4, v6
    v_xor_b32 v7, 32, v6
    v_xor_b32 v14, 64, v6
    v_xor_b32 v15, 96, v6
    v_add_u32 v48, 32768, v6
    v_add_u32 v49, 32768, v7
    v_add_u32 v50, 32768, v14
    v_add_u32 v51, 32768, v15
    v_lshrrev_b32 v1, 5, v0
    v_lshlrev_b32 v1, 3, v1
    v_bfe_u32 v9, v0, 2, 2
    v_add_u32 v1, v1, v9
    v_lshlrev_b32 v8, 7, v1
    v_and_b32 v1, 1, v0
    v_lshlrev_b32 v1, 1, v1
    v_bfe_u32 v9, v0, 1, 1
    v_or_b32 v1, v1, v9
    v_lshlrev_b32 v1, 3, v1
    v_bfe_u32 v9, v0, 4, 1
    v_lshl_add_u32 v1, v9, 5, v1
    s_lshr_b32 s26, s20, 1
    s_lshl_b32 s26, s26, 6
    v_add_u32 v1, s26, v1
    v_bfe_u32 v9, v0, 3, 1
    v_lshlrev_b32 v9, 6, v9
    v_xor_b32 v1, v1, v9
    v_add_u32 v8, v8, v1
    v_add_u32 v8, 49152, v8
    v_mov_b32 v64, 0
    v_mov_b32 v65, 0
    v_mov_b32 v66, 0
    v_mov_b32 v67, 0
    v_mov_b32 v68, 0
    v_mov_b32 v69, 0
    v_mov_b32 v70, 0
    v_mov_b32 v71, 0
    v_mov_b32 v72, 0
    v_mov_b32 v73, 0
    v_mov_b32 v74, 0
    v_mov_b32 v75, 0
    v_mov_b32 v76, 0
    v_mov_b32 v77, 0
    v_mov_b32 v78, 0
    v_mov_b32 v79, 0
    v_mov_b32 v80, 0
    v_mov_b32 v81, 0
    v_mov_b32 v82, 0
    v_mov_b32 v83, 0
    v_mov_b32 v84, 0
    v_mov_b32 v85, 0
    v_mov_b32 v86, 0
    v_mov_b32 v87, 0
    v_mov_b32 v88, 0
    v_mov_b32 v89, 0
    v_mov_b32 v90, 0
    v_mov_b32 v91, 0
    v_mov_b32 v92, 0
    v_mov_b32 v93, 0
    v_mov_b32 v94, 0
    v_mov_b32 v95, 0
    v_mov_b32 v96, 0
    v_mov_b32 v97, 0
    v_mov_b32 v98, 0
    v_mov_b32 v99, 0
    v_mov_b32 v100, 0
    v_mov_b32 v101, 0
    v_mov_b32 v102, 0
    v_mov_b32 v103, 0
    v_mov_b32 v104, 0
    v_mov_b32 v105, 0
    v_mov_b32 v106, 0
    v_mov_b32 v107, 0
    v_mov_b32 v108, 0
    v_mov_b32 v109, 0
    v_mov_b32 v110, 0
    v_mov_b32 v111, 0
    v_mov_b32 v112, 0
    v_mov_b32 v113, 0
    v_mov_b32 v114, 0
    v_mov_b32 v115, 0
    v_mov_b32 v116, 0
    v_mov_b32 v117, 0
    v_mov_b32 v118, 0
    v_mov_b32 v119, 0
    v_mov_b32 v120, 0
    v_mov_b32 v121, 0
    v_mov_b32 v122, 0
    v_mov_b32 v123, 0
    v_mov_b32 v124, 0
    v_mov_b32 v125, 0
    v_mov_b32 v126, 0
    v_mov_b32 v127, 0
    s_waitcnt vmcnt(4)
    s_barrier
    ds_read_b128 v[16:19], v6 offset:0
    ds_read_b128 v[20:23], v6 offset:4096
    ds_read_b64_tr_b16 v[24:25], v8 offset:0
    ds_read_b64_tr_b16 v[26:27], v8 offset:512
    ds_read_b64_tr_b16 v[28:29], v8 offset:8192
    ds_read_b64_tr_b16 v[30:31], v8 offset:8704
    ds_read_b128 v[32:35], v7 offset:0
    ds_read_b128 v[36:39], v7 offset:4096
    ds_read_b64_tr_b16 v[40:41], v8 offset:2048
    ds_read_b64_tr_b16 v[42:43], v8 offset:2560
    ds_read_b64_tr_b16 v[44:45], v8 offset:10240
    ds_read_b64_tr_b16 v[46:47], v8 offset:10752
    s_waitcnt lgkmcnt(6)
    v_mfma_f32_32x32x16_bf16 v[64:79], v[24:27], v[16:19], v[64:79]
    s_add_u32 m0, s38, 65536
    s_nop 0
    buffer_load_dwordx4 v10, s[8:11], s30 offen lds
    v_mfma_f32_32x32x16_bf16 v[80:95], v[28:31], v[16:19], v[80:95]
    v_mfma_f32_32x32x16_bf16 v[96:111], v[24:27], v[20:23], v[96:111]
    s_add_u32 m0, s38, 66560
    s_nop 0
    buffer_load_dwordx4 v11, s[8:11], s30 offen lds
    v_mfma_f32_32x32x16_bf16 v[112:127], v[28:31], v[20:23], v[112:127]
    ds_read_b128 v[16:19], v14 offset:0
    ds_read_b128 v[20:23], v14 offset:4096
    ds_read_b64_tr_b16 v[24:25], v8 offset:4096
    ds_read_b64_tr_b16 v[26:27], v8 offset:4608
    ds_read_b64_tr_b16 v[28:29], v8 offset:12288
    ds_read_b64_tr_b16 v[30:31], v8 offset:12800
    s_waitcnt lgkmcnt(6)
    v_mfma_f32_32x32x16_bf16 v[64:79], v[40:43], v[32:35], v[64:79]
    s_add_u32 m0, s38, 67584
    s_nop 0
    buffer_load_dwordx4 v12, s[8:11], s30 offen lds
    v_mfma_f32_32x32x16_bf16 v[80:95], v[44:47], v[32:35], v[80:95]
    v_mfma_f32_32x32x16_bf16 v[96:111], v[40:43], v[36:39], v[96:111]
    s_add_u32 m0, s38, 68608
    s_nop 0
    buffer_load_dwordx4 v13, s[8:11], s30 offen lds
    s_add_u32 s30, s30, 81920
    s_cmp_eq_u32 s30, 983040
    s_cselect_b32 s30, 0, s30
    v_mfma_f32_32x32x16_bf16 v[112:127], v[44:47], v[36:39], v[112:127]
    ds_read_b128 v[32:35], v15 offset:0
    ds_read_b128 v[36:39], v15 offset:4096
    ds_read_b64_tr_b16 v[40:41], v8 offset:6144
    ds_read_b64_tr_b16 v[42:43], v8 offset:6656
    ds_read_b64_tr_b16 v[44:45], v8 offset:14336
    ds_read_b64_tr_b16 v[46:47], v8 offset:14848
    s_waitcnt lgkmcnt(6)
    v_mfma_f32_32x32x16_bf16 v[64:79], v[24:27], v[16:19], v[64:79]
    s_add_u32 m0, s28, 32768
    s_nop 0
    buffer_load_dwordx4 v2, s[4:7], s29 offen lds
    v_mfma_f32_32x32x16_bf16 v[80:95], v[28:31], v[16:19], v[80:95]
    v_mfma_f32_32x32x16_bf16 v[96:111], v[24:27], v[20:23], v[96:111]
    s_add_u32 m0, s28, 33792
    s_nop 0
    buffer_load_dwordx4 v3, s[4:7], s29 offen lds
    v_mfma_f32_32x32x16_bf16 v[112:127], v[28:31], v[20:23], v[112:127]
    s_waitcnt lgkmcnt(0)
    v_mfma_f32_32x32x16_bf16 v[64:79], v[40:43], v[32:35], v[64:79]
    s_add_u32 m0, s28, 34816
    s_nop 0
    buffer_load_dwordx4 v4, s[4:7], s29 offen lds
    v_mfma_f32_32x32x16_bf16 v[80:95], v[44:47], v[32:35], v[80:95]
    v_mfma_f32_32x32x16_bf16 v[96:111], v[40:43], v[36:39], v[96:111]
    s_add_u32 m0, s28, 35840
    s_nop 0
    buffer_load_dwordx4 v5, s[4:7], s29 offen lds
    s_add_u32 s29, s29, 128
    s_cmp_eq_u32 s29, 1536
    s_cselect_b32 s29, 0, s29
    v_mfma_f32_32x32x16_bf16 v[112:127], v[44:47], v[36:39], v[112:127]
    s_waitcnt vmcnt(4)
    s_barrier
    ds_read_b128 v[16:19], v6 offset:16384
    ds_read_b128 v[20:23], v6 offset:20480
    ds_read_b64_tr_b16 v[24:25], v8 offset:16384
    ds_read_b64_tr_b16 v[26:27], v8 offset:16896
    ds_read_b64_tr_b16 v[28:29], v8 offset:24576
    ds_read_b64_tr_b16 v[30:31], v8 offset:25088
    ds_read_b128 v[32:35], v7 offset:16384
    ds_read_b128 v[36:39], v7 offset:20480
    ds_read_b64_tr_b16 v[40:41], v8 offset:18432
    ds_read_b64_tr_b16 v[42:43], v8 offset:18944
    ds_read_b64_tr_b16 v[44:45], v8 offset:26624
    ds_read_b64_tr_b16 v[46:47], v8 offset:27136
    s_waitcnt lgkmcnt(6)
    v_mfma_f32_32x32x16_bf16 v[64:79], v[24:27], v[16:19], v[64:79]
    s_add_u32 m0, s38, 49152
    s_nop 0
    buffer_load_dwordx4 v10, s[8:11], s30 offen lds
    v_mfma_f32_32x32x16_bf16 v[80:95], v[28:31], v[16:19], v[80:95]
    v_mfma_f32_32x32x16_bf16 v[96:111], v[24:27], v[20:23], v[96:111]
    s_add_u32 m0, s38, 50176
    s_nop 0
    buffer_load_dwordx4 v11, s[8:11], s30 offen lds
    v_mfma_f32_32x32x16_bf16 v[112:127], v[28:31], v[20:23], v[112:127]
    ds_read_b128 v[16:19], v14 offset:16384
    ds_read_b128 v[20:23], v14 offset:20480
    ds_read_b64_tr_b16 v[24:25], v8 offset:20480
    ds_read_b64_tr_b16 v[26:27], v8 offset:20992
    ds_read_b64_tr_b16 v[28:29], v8 offset:28672
    ds_read_b64_tr_b16 v[30:31], v8 offset:29184
    s_waitcnt lgkmcnt(6)
    v_mfma_f32_32x32x16_bf16 v[64:79], v[40:43], v[32:35], v[64:79]
    s_add_u32 m0, s38, 51200
    s_nop 0
    buffer_load_dwordx4 v12, s[8:11], s30 offen lds
    v_mfma_f32_32x32x16_bf16 v[80:95], v[44:47], v[32:35], v[80:95]
    v_mfma_f32_32x32x16_bf16 v[96:111], v[40:43], v[36:39], v[96:111]
    s_add_u32 m0, s38, 52224
    s_nop 0
    buffer_load_dwordx4 v13, s[8:11], s30 offen lds
    s_add_u32 s30, s30, 81920
    s_cmp_eq_u32 s30, 983040
    s_cselect_b32 s30, 0, s30
    v_mfma_f32_32x32x16_bf16 v[112:127], v[44:47], v[36:39], v[112:127]
    ds_read_b128 v[32:35], v15 offset:16384
    ds_read_b128 v[36:39], v15 offset:20480
    ds_read_b64_tr_b16 v[40:41], v8 offset:22528
    ds_read_b64_tr_b16 v[42:43], v8 offset:23040
    ds_read_b64_tr_b16 v[44:45], v8 offset:30720
    ds_read_b64_tr_b16 v[46:47], v8 offset:31232
    s_waitcnt lgkmcnt(6)
    v_mfma_f32_32x32x16_bf16 v[64:79], v[24:27], v[16:19], v[64:79]
    s_add_u32 m0, s28, 0
    s_nop 0
    buffer_load_dwordx4 v2, s[4:7], s29 offen lds
    v_mfma_f32_32x32x16_bf16 v[80:95], v[28:31], v[16:19], v[80:95]
    v_mfma_f32_32x32x16_bf16 v[96:111], v[24:27], v[20:23], v[96:111]
    s_add_u32 m0, s28, 1024
    s_nop 0
    buffer_load_dwordx4 v3, s[4:7], s29 offen lds
    v_mfma_f32_32x32x16_bf16 v[112:127], v[28:31], v[20:23], v[112:127]
    s_waitcnt lgkmcnt(0)
    v_mfma_f32_32x32x16_bf16 v[64:79], v[40:43], v[32:35], v[64:79]
    s_add_u32 m0, s28, 2048
    s_nop 0
    buffer_load_dwordx4 v4, s[4:7], s29 offen lds
    v_mfma_f32_32x32x16_bf16 v[80:95], v[44:47], v[32:35], v[80:95]
    v_mfma_f32_32x32x16_bf16 v[96:111], v[40:43], v[36:39], v[96:111]
    s_add_u32 m0, s28, 3072
    s_nop 0
    buffer_load_dwordx4 v5, s[4:7], s29 offen lds
    s_add_u32 s29, s29, 128
    s_cmp_eq_u32 s29, 1536
    s_cselect_b32 s29, 0, s29
    v_mfma_f32_32x32x16_bf16 v[112:127], v[44:47], v[36:39], v[112:127]
    s_waitcnt vmcnt(4)
    s_barrier
    ds_read_b128 v[16:19], v48 offset:0
    ds_read_b128 v[20:23], v48 offset:4096
    ds_read_b64_tr_b16 v[24:25], v8 offset:0
    ds_read_b64_tr_b16 v[26:27], v8 offset:512
    ds_read_b64_tr_b16 v[28:29], v8 offset:8192
    ds_read_b64_tr_b16 v[30:31], v8 offset:8704
    ds_read_b128 v[32:35], v49 offset:0
    ds_read_b128 v[36:39], v49 offset:4096
    ds_read_b64_tr_b16 v[40:41], v8 offset:2048
    ds_read_b64_tr_b16 v[42:43], v8 offset:2560
    ds_read_b64_tr_b16 v[44:45], v8 offset:10240
    ds_read_b64_tr_b16 v[46:47], v8 offset:10752
    s_waitcnt lgkmcnt(6)
    v_mfma_f32_32x32x16_bf16 v[64:79], v[24:27], v[16:19], v[64:79]
    s_add_u32 m0, s38, 65536
    s_nop 0
    buffer_load_dwordx4 v10, s[8:11], s30 offen lds
    v_mfma_f32_32x32x16_bf16 v[80:95], v[28:31], v[16:19], v[80:95]
    v_mfma_f32_32x32x16_bf16 v[96:111], v[24:27], v[20:23], v[96:111]
    s_add_u32 m0, s38, 66560
    s_nop 0
    buffer_load_dwordx4 v11, s[8:11], s30 offen lds
    v_mfma_f32_32x32x16_bf16 v[112:127], v[28:31], v[20:23], v[112:127]
    ds_read_b128 v[16:19], v50 offset:0
    ds_read_b128 v[20:23], v50 offset:4096
    ds_read_b64_tr_b16 v[24:25], v8 offset:4096
    ds_read_b64_tr_b16 v[26:27], v8 offset:4608
    ds_read_b64_tr_b16 v[28:29], v8 offset:12288
    ds_read_b64_tr_b16 v[30:31], v8 offset:12800
    s_waitcnt lgkmcnt(6)
    v_mfma_f32_32x32x16_bf16 v[64:79], v[40:43], v[32:35], v[64:79]
    s_add_u32 m0, s38, 67584
    s_nop 0
    buffer_load_dwordx4 v12, s[8:11], s30 offen lds
    v_mfma_f32_32x32x16_bf16 v[80:95], v[44:47], v[32:35], v[80:95]
    v_mfma_f32_32x32x16_bf16 v[96:111], v[40:43], v[36:39], v[96:111]
    s_add_u32 m0, s38, 68608
    s_nop 0
    buffer_load_dwordx4 v13, s[8:11], s30 offen lds
    s_add_u32 s30, s30, 81920
    s_cmp_eq_u32 s30, 983040
    s_cselect_b32 s30, 0, s30
    v_mfma_f32_32x32x16_bf16 v[112:127], v[44:47], v[36:39], v[112:127]
    ds_read_b128 v[32:35], v51 offset:0
    ds_read_b128 v[36:39], v51 offset:4096
    ds_read_b64_tr_b16 v[40:41], v8 offset:6144
    ds_read_b64_tr_b16 v[42:43], v8 offset:6656
    ds_read_b64_tr_b16 v[44:45], v8 offset:14336
    ds_read_b64_tr_b16 v[46:47], v8 offset:14848
    s_waitcnt lgkmcnt(6)
    v_mfma_f32_32x32x16_bf16 v[64:79], v[24:27], v[16:19], v[64:79]
    s_add_u32 m0, s28, 16384
    s_nop 0
    buffer_load_dwordx4 v2, s[4:7], s29 offen lds
    v_mfma_f32_32x32x16_bf16 v[80:95], v[28:31], v[16:19], v[80:95]
    v_mfma_f32_32x32x16_bf16 v[96:111], v[24:27], v[20:23], v[96:111]
    s_add_u32 m0, s28, 17408
    s_nop 0
    buffer_load_dwordx4 v3, s[4:7], s29 offen lds
    v_mfma_f32_32x32x16_bf16 v[112:127], v[28:31], v[20:23], v[112:127]
    s_waitcnt lgkmcnt(0)
    v_mfma_f32_32x32x16_bf16 v[64:79], v[40:43], v[32:35], v[64:79]
    s_add_u32 m0, s28, 18432
    s_nop 0
    buffer_load_dwordx4 v4, s[4:7], s29 offen lds
    v_mfma_f32_32x32x16_bf16 v[80:95], v[44:47], v[32:35], v[80:95]
    v_mfma_f32_32x32x16_bf16 v[96:111], v[40:43], v[36:39], v[96:111]
    s_add_u32 m0, s28, 19456
    s_nop 0
    buffer_load_dwordx4 v5, s[4:7], s29 offen lds
    s_add_u32 s29, s29, 128
    s_cmp_eq_u32 s29, 1536
    s_cselect_b32 s29, 0, s29
    v_mfma_f32_32x32x16_bf16 v[112:127], v[44:47], v[36:39], v[112:127]
    s_waitcnt vmcnt(4)
    s_barrier
    ds_read_b128 v[16:19], v6 offset:0
    ds_read_b128 v[20:23], v6 offset:4096
    ds_read_b64_tr_b16 v[24:25], v8 offset:16384
    ds_read_b64_tr_b16 v[26:27], v8 offset:16896
    ds_read_b64_tr_b16 v[28:29], v8 offset:24576
    ds_read_b64_tr_b16 v[30:31], v8 offset:25088
    ds_read_b128 v[32:35], v7 offset:0
    ds_read_b128 v[36:39], v7 offset:4096
    ds_read_b64_tr_b16 v[40:41], v8 offset:18432
    ds_read_b64_tr_b16 v[42:43], v8 offset:18944
    ds_read_b64_tr_b16 v[44:45], v8 offset:26624
    ds_read_b64_tr_b16 v[46:47], v8 offset:27136
    s_waitcnt lgkmcnt(6)
    v_mfma_f32_32x32x16_bf16 v[64:79], v[24:27], v[16:19], v[64:79]
    s_add_u32 m0, s38, 49152
    s_nop 0
    buffer_load_dwordx4 v10, s[8:11], s30 offen lds
    v_mfma_f32_32x32x16_bf16 v[80:95], v[28:31], v[16:19], v[80:95]
    v_mfma_f32_32x32x16_bf16 v[96:111], v[24:27], v[20:23], v[96:111]
    s_add_u32 m0, s38, 50176
    s_nop 0
    buffer_load_dwordx4 v11, s[8:11], s30 offen lds
    v_mfma_f32_32x32x16_bf16 v[112:127], v[28:31], v[20:23], v[112:127]
    ds_read_b128 v[16:19], v14 offset:0
    ds_read_b128 v[20:23], v14 offset:4096
    ds_read_b64_tr_b16 v[24:25], v8 offset:20480
    ds_read_b64_tr_b16 v[26:27], v8 offset:20992
    ds_read_b64_tr_b16 v[28:29], v8 offset:28672
    ds_read_b64_tr_b16 v[30:31], v8 offset:29184
    s_waitcnt lgkmcnt(6)
    v_mfma_f32_32x32x16_bf16 v[64:79], v[40:43], v[32:35], v[64:79]
    s_add_u32 m0, s38, 51200
    s_nop 0
    buffer_load_dwordx4 v12, s[8:11], s30 offen lds
    v_mfma_f32_32x32x16_bf16 v[80:95], v[44:47], v[32:35], v[80:95]
    v_mfma_f32_32x32x16_bf16 v[96:111], v[40:43], v[36:39], v[96:111]
    s_add_u32 m0, s38, 52224
    s_nop 0
    buffer_load_dwordx4 v13, s[8:11], s30 offen lds
    s_add_u32 s30, s30, 81920
    s_cmp_eq_u32 s30, 983040
    s_cselect_b32 s30, 0, s30
    v_mfma_f32_32x32x16_bf16 v[112:127], v[44:47], v[36:39], v[112:127]
    ds_read_b128 v[32:35], v15 offset:0
    ds_read_b128 v[36:39], v15 offset:4096
    ds_read_b64_tr_b16 v[40:41], v8 offset:22528
    ds_read_b64_tr_b16 v[42:43], v8 offset:23040
    ds_read_b64_tr_b16 v[44:45], v8 offset:30720
    ds_read_b64_tr_b16 v[46:47], v8 offset:31232
    s_waitcnt lgkmcnt(6)
    v_mfma_f32_32x32x16_bf16 v[64:79], v[24:27], v[16:19], v[64:79]
    s_add_u32 m0, s28, 32768
    s_nop 0
    buffer_load_dwordx4 v2, s[4:7], s29 offen lds
    v_mfma_f32_32x32x16_bf16 v[80:95], v[28:31], v[16:19], v[80:95]
    v_mfma_f32_32x32x16_bf16 v[96:111], v[24:27], v[20:23], v[96:111]
    s_add_u32 m0, s28, 33792
    s_nop 0
    buffer_load_dwordx4 v3, s[4:7], s29 offen lds
    v_mfma_f32_32x32x16_bf16 v[112:127], v[28:31], v[20:23], v[112:127]
    s_waitcnt lgkmcnt(0)
    v_mfma_f32_32x32x16_bf16 v[64:79], v[40:43], v[32:35], v[64:79]
    s_add_u32 m0, s28, 34816
    s_nop 0
    buffer_load_dwordx4 v4, s[4:7], s29 offen lds
    v_mfma_f32_32x32x16_bf16 v[80:95], v[44:47], v[32:35], v[80:95]
    v_mfma_f32_32x32x16_bf16 v[96:111], v[40:43], v[36:39], v[96:111]
    s_add_u32 m0, s28, 35840
    s_nop 0
    buffer_load_dwordx4 v5, s[4:7], s29 offen lds
    s_add_u32 s29, s29, 128
    s_cmp_eq_u32 s29, 1536
    s_cselect_b32 s29, 0, s29
    v_mfma_f32_32x32x16_bf16 v[112:127], v[44:47], v[36:39], v[112:127]
    s_waitcnt vmcnt(4)
    s_barrier
    ds_read_b128 v[16:19], v6 offset:16384
    ds_read_b128 v[20:23], v6 offset:20480
    ds_read_b64_tr_b16 v[24:25], v8 offset:0
    ds_read_b64_tr_b16 v[26:27], v8 offset:512
    ds_read_b64_tr_b16 v[28:29], v8 offset:8192
    ds_read_b64_tr_b16 v[30:31], v8 offset:8704
    ds_read_b128 v[32:35], v7 offset:16384
    ds_read_b128 v[36:39], v7 offset:20480
    ds_read_b64_tr_b16 v[40:41], v8 offset:2048
    ds_read_b64_tr_b16 v[42:43], v8 offset:2560
    ds_read_b64_tr_b16 v[44:45], v8 offset:10240
    ds_read_b64_tr_b16 v[46:47], v8 offset:10752
    s_waitcnt lgkmcnt(6)
    v_mfma_f32_32x32x16_bf16 v[64:79], v[24:27], v[16:19], v[64:79]
    s_add_u32 m0, s38, 65536
    s_nop 0
    buffer_load_dwordx4 v10, s[8:11], s30 offen lds
    v_mfma_f32_32x32x16_bf16 v[80:95], v[28:31], v[16:19], v[80:95]
    v_mfma_f32_32x32x16_bf16 v[96:111], v[24:27], v[20:23], v[96:111]
    s_add_u32 m0, s38, 66560
    s_nop 0
    buffer_load_dwordx4 v11, s[8:11], s30 offen lds
    v_mfma_f32_32x32x16_bf16 v[112:127], v[28:31], v[20:23], v[112:127]
    ds_read_b128 v[16:19], v14 offset:16384
    ds_read_b128 v[20:23], v14 offset:20480
    ds_read_b64_tr_b16 v[24:25], v8 offset:4096
    ds_read_b64_tr_b16 v[26:27], v8 offset:4608
    ds_read_b64_tr_b16 v[28:29], v8 offset:12288
    ds_read_b64_tr_b16 v[30:31], v8 offset:12800
    s_waitcnt lgkmcnt(6)
    v_mfma_f32_32x32x16_bf16 v[64:79], v[40:43], v[32:35], v[64:79]
    s_add_u32 m0, s38, 67584
    s_nop 0
    buffer_load_dwordx4 v12, s[8:11], s30 offen lds
    v_mfma_f32_32x32x16_bf16 v[80:95], v[44:47], v[32:35], v[80:95]
    v_mfma_f32_32x32x16_bf16 v[96:111], v[40:43], v[36:39], v[96:111]
    s_add_u32 m0, s38, 68608
    s_nop 0
    buffer_load_dwordx4 v13, s[8:11], s30 offen lds
    s_add_u32 s30, s30, 81920
    s_cmp_eq_u32 s30, 983040
    s_cselect_b32 s30, 0, s30
    v_mfma_f32_32x32x16_bf16 v[112:127], v[44:47], v[36:39], v[112:127]
    ds_read_b128 v[32:35], v15 offset:16384
    ds_read_b128 v[36:39], v15 offset:20480
    ds_read_b64_tr_b16 v[40:41], v8 offset:6144
    ds_read_b64_tr_b16 v[42:43], v8 offset:6656
    ds_read_b64_tr_b16 v[44:45], v8 offset:14336
    ds_read_b64_tr_b16 v[46:47], v8 offset:14848
    s_waitcnt lgkmcnt(6)
    v_mfma_f32_32x32x16_bf16 v[64:79], v[24:27], v[16:19], v[64:79]
    s_add_u32 m0, s28, 0
    s_nop 0
    buffer_load_dwordx4 v2, s[4:7], s29 offen lds
    v_mfma_f32_32x32x16_bf16 v[80:95], v[28:31], v[16:19], v[80:95]
    v_mfma_f32_32x32x16_bf16 v[96:111], v[24:27], v[20:23], v[96:111]
    s_add_u32 m0, s28, 1024
    s_nop 0
    buffer_load_dwordx4 v3, s[4:7], s29 offen lds
    v_mfma_f32_32x32x16_bf16 v[112:127], v[28:31], v[20:23], v[112:127]
    s_waitcnt lgkmcnt(0)
    v_mfma_f32_32x32x16_bf16 v[64:79], v[40:43], v[32:35], v[64:79]
    s_add_u32 m0, s28, 2048
    s_nop 0
    buffer_load_dwordx4 v4, s[4:7], s29 offen lds
    v_mfma_f32_32x32x16_bf16 v[80:95], v[44:47], v[32:35], v[80:95]
    v_mfma_f32_32x32x16_bf16 v[96:111], v[40:43], v[36:39], v[96:111]
    s_add_u32 m0, s28, 3072
    s_nop 0
    buffer_load_dwordx4 v5, s[4:7], s29 offen lds
    s_add_u32 s29, s29, 128
    s_cmp_eq_u32 s29, 1536
    s_cselect_b32 s29, 0, s29
    v_mfma_f32_32x32x16_bf16 v[112:127], v[44:47], v[36:39], v[112:127]
    s_waitcnt vmcnt(4)
    s_barrier
    ds_read_b128 v[16:19], v48 offset:0
    ds_read_b128 v[20:23], v48 offset:4096
    ds_read_b64_tr_b16 v[24:25], v8 offset:16384
    ds_read_b64_tr_b16 v[26:27], v8 offset:16896
    ds_read_b64_tr_b16 v[28:29], v8 offset:24576
    ds_read_b64_tr_b16 v[30:31], v8 offset:25088
    ds_read_b128 v[32:35], v49 offset:0
    ds_read_b128 v[36:39], v49 offset:4096
    ds_read_b64_tr_b16 v[40:41], v8 offset:18432
    ds_read_b64_tr_b16 v[42:43], v8 offset:18944
    ds_read_b64_tr_b16 v[44:45], v8 offset:26624
    ds_read_b64_tr_b16 v[46:47], v8 offset:27136
    s_waitcnt lgkmcnt(6)
    v_mfma_f32_32x32x16_bf16 v[64:79], v[24:27], v[16:19], v[64:79]
    s_add_u32 m0, s38, 49152
    s_nop 0
    buffer_load_dwordx4 v10, s[8:11], s30 offen lds
    v_mfma_f32_32x32x16_bf16 v[80:95], v[28:31], v[16:19], v[80:95]
    v_mfma_f32_32x32x16_bf16 v[96:111], v[24:27], v[20:23], v[96:111]
    s_add_u32 m0, s38, 50176
    s_nop 0
    buffer_load_dwordx4 v11, s[8:11], s30 offen lds
    v_mfma_f32_32x32x16_bf16 v[112:127], v[28:31], v[20:23], v[112:127]
    ds_read_b128 v[16:19], v50 offset:0
    ds_read_b128 v[20:23], v50 offset:4096
    ds_read_b64_tr_b16 v[24:25], v8 offset:20480
    ds_read_b64_tr_b16 v[26:27], v8 offset:20992
    ds_read_b64_tr_b16 v[28:29], v8 offset:28672
    ds_read_b64_tr_b16 v[30:31], v8 offset:29184
    s_waitcnt lgkmcnt(6)
    v_mfma_f32_32x32x16_bf16 v[64:79], v[40:43], v[32:35], v[64:79]
    s_add_u32 m0, s38, 51200
    s_nop 0
    buffer_load_dwordx4 v12, s[8:11], s30 offen lds
    v_mfma_f32_32x32x16_bf16 v[80:95], v[44:47], v[32:35], v[80:95]
    v_mfma_f32_32x32x16_bf16 v[96:111], v[40:43], v[36:39], v[96:111]
    s_add_u32 m0, s38, 52224
    s_nop 0
    buffer_load_dwordx4 v13, s[8:11], s30 offen lds
    s_add_u32 s30, s30, 81920
    s_cmp_eq_u32 s30, 983040
    s_cselect_b32 s30, 0, s30
    v_mfma_f32_32x32x16_bf16 v[112:127], v[44:47], v[36:39], v[112:127]
    ds_read_b128 v[32:35], v51 offset:0
    ds_read_b128 v[36:39], v51 offset:4096
    ds_read_b64_tr_b16 v[40:41], v8 offset:22528
    ds_read_b64_tr_b16 v[42:43], v8 offset:23040
    ds_read_b64_tr_b16 v[44:45], v8 offset:30720
    ds_read_b64_tr_b16 v[46:47], v8 offset:31232
    s_waitcnt lgkmcnt(6)
    v_mfma_f32_32x32x16_bf16 v[64:79], v[24:27], v[16:19], v[64:79]
    s_add_u32 m0, s28, 16384
    s_nop 0
    buffer_load_dwordx4 v2, s[4:7], s29 offen lds
    v_mfma_f32_32x32x16_bf16 v[80:95], v[28:31], v[16:19], v[80:95]
    v_mfma_f32_32x32x16_bf16 v[96:111], v[24:27], v[20:23], v[96:111]
    s_add_u32 m0, s28, 17408
    s_nop 0
    buffer_load_dwordx4 v3, s[4:7], s29 offen lds
    v_mfma_f32_32x32x16_bf16 v[112:127], v[28:31], v[20:23], v[112:127]
    s_waitcnt lgkmcnt(0)
    v_mfma_f32_32x32x16_bf16 v[64:79], v[40:43], v[32:35], v[64:79]
    s_add_u32 m0, s28, 18432
    s_nop 0
    buffer_load_dwordx4 v4, s[4:7], s29 offen lds
    v_mfma_f32_32x32x16_bf16 v[80:95], v[44:47], v[32:35], v[80:95]
    v_mfma_f32_32x32x16_bf16 v[96:111], v[40:43], v[36:39], v[96:111]
    s_add_u32 m0, s28, 19456
    s_nop 0
    buffer_load_dwordx4 v5, s[4:7], s29 offen lds
    s_add_u32 s29, s29, 128
    s_cmp_eq_u32 s29, 1536
    s_cselect_b32 s29, 0, s29
    v_mfma_f32_32x32x16_bf16 v[112:127], v[44:47], v[36:39], v[112:127]
    s_waitcnt vmcnt(4)
    s_barrier
    ds_read_b128 v[16:19], v6 offset:0
    ds_read_b128 v[20:23], v6 offset:4096
    ds_read_b64_tr_b16 v[24:25], v8 offset:0
    ds_read_b64_tr_b16 v[26:27], v8 offset:512
    ds_read_b64_tr_b16 v[28:29], v8 offset:8192
    ds_read_b64_tr_b16 v[30:31], v8 offset:8704
    ds_read_b128 v[32:35], v7 offset:0
    ds_read_b128 v[36:39], v7 offset:4096
    ds_read_b64_tr_b16 v[40:41], v8 offset:2048
    ds_read_b64_tr_b16 v[42:43], v8 offset:2560
    ds_read_b64_tr_b16 v[44:45], v8 offset:10240
    ds_read_b64_tr_b16 v[46:47], v8 offset:10752
    s_waitcnt lgkmcnt(6)
    v_mfma_f32_32x32x16_bf16 v[64:79], v[24:27], v[16:19], v[64:79]
    s_add_u32 m0, s38, 65536
    s_nop 0
    buffer_load_dwordx4 v10, s[8:11], s30 offen lds
    v_mfma_f32_32x32x16_bf16 v[80:95], v[28:31], v[16:19], v[80:95]
    v_mfma_f32_32x32x16_bf16 v[96:111], v[24:27], v[20:23], v[96:111]
    s_add_u32 m0, s38, 66560
    s_nop 0
    buffer_load_dwordx4 v11, s[8:11], s30 offen lds
    v_mfma_f32_32x32x16_bf16 v[112:127], v[28:31], v[20:23], v[112:127]
    ds_read_b128 v[16:19], v14 offset:0
    ds_read_b128 v[20:23], v14 offset:4096
    ds_read_b64_tr_b16 v[24:25], v8 offset:4096
    ds_read_b64_tr_b16 v[26:27], v8 offset:4608
    ds_read_b64_tr_b16 v[28:29], v8 offset:12288
    ds_read_b64_tr_b16 v[30:31], v8 offset:12800
    s_waitcnt lgkmcnt(6)
    v_mfma_f32_32x32x16_bf16 v[64:79], v[40:43], v[32:35], v[64:79]
    s_add_u32 m0, s38, 67584
    s_nop 0
    buffer_load_dwordx4 v12, s[8:11], s30 offen lds
    v_mfma_f32_32x32x16_bf16 v[80:95], v[44:47], v[32:35], v[80:95]
    v_mfma_f32_32x32x16_bf16 v[96:111], v[40:43], v[36:39], v[96:111]
    s_add_u32 m0, s38, 68608
    s_nop 0
    buffer_load_dwordx4 v13, s[8:11], s30 offen lds
    s_add_u32 s30, s30, 81920
    s_cmp_eq_u32 s30, 983040
    s_cselect_b32 s30, 0, s30
    v_mfma_f32_32x32x16_bf16 v[112:127], v[44:47], v[36:39], v[112:127]
    ds_read_b128 v[32:35], v15 offset:0
    ds_read_b128 v[36:39], v15 offset:4096
    ds_read_b64_tr_b16 v[40:41], v8 offset:6144
    ds_read_b64_tr_b16 v[42:43], v8 offset:6656
    ds_read_b64_tr_b16 v[44:45], v8 offset:14336
    ds_read_b64_tr_b16 v[46:47], v8 offset:14848
    s_waitcnt lgkmcnt(6)
    v_mfma_f32_32x32x16_bf16 v[64:79], v[24:27], v[16:19], v[64:79]
    s_add_u32 m0, s28, 32768
    s_nop 0
    buffer_load_dwordx4 v2, s[4:7], s29 offen lds
    v_mfma_f32_32x32x16_bf16 v[80:95], v[28:31], v[16:19], v[80:95]
    v_mfma_f32_32x32x16_bf16 v[96:111], v[24:27], v[20:23], v[96:111]
    s_add_u32 m0, s28, 33792
    s_nop 0
    buffer_load_dwordx4 v3, s[4:7], s29 offen lds
    v_mfma_f32_32x32x16_bf16 v[112:127], v[28:31], v[20:23], v[112:127]
    s_waitcnt lgkmcnt(0)
    v_mfma_f32_32x32x16_bf16 v[64:79], v[40:43], v[32:35], v[64:79]
    s_add_u32 m0, s28, 34816
    s_nop 0
    buffer_load_dwordx4 v4, s[4:7], s29 offen lds
    v_mfma_f32_32x32x16_bf16 v[80:95], v[44:47], v[32:35], v[80:95]
    v_mfma_f32_32x32x16_bf16 v[96:111], v[40:43], v[36:39], v[96:111]
    s_add_u32 m0, s28, 35840
    s_nop 0
    buffer_load_dwordx4 v5, s[4:7], s29 offen lds
    s_add_u32 s29, s29, 128
    s_cmp_eq_u32 s29, 1536
    s_cselect_b32 s29, 0, s29
    v_mfma_f32_32x32x16_bf16 v[112:127], v[44:47], v[36:39], v[112:127]
    s_waitcnt vmcnt(4)
    s_barrier
    ds_read_b128 v[16:19], v6 offset:16384
    ds_read_b128 v[20:23], v6 offset:20480
    ds_read_b64_tr_b16 v[24:25], v8 offset:16384
    ds_read_b64_tr_b16 v[26:27], v8 offset:16896
    ds_read_b64_tr_b16 v[28:29], v8 offset:24576
    ds_read_b64_tr_b16 v[30:31], v8 offset:25088
    ds_read_b128 v[32:35], v7 offset:16384
    ds_read_b128 v[36:39], v7 offset:20480
    ds_read_b64_tr_b16 v[40:41], v8 offset:18432
    ds_read_b64_tr_b16 v[42:43], v8 offset:18944
    ds_read_b64_tr_b16 v[44:45], v8 offset:26624
    ds_read_b64_tr_b16 v[46:47], v8 offset:27136
    s_waitcnt lgkmcnt(6)
    v_mfma_f32_32x32x16_bf16 v[64:79], v[24:27], v[16:19], v[64:79]
    s_add_u32 m0, s38, 49152
    s_nop 0
    buffer_load_dwordx4 v10, s[8:11], s30 offen lds
    v_mfma_f32_32x32x16_bf16 v[80:95], v[28:31], v[16:19], v[80:95]
    v_mfma_f32_32x32x16_bf16 v[96:111], v[24:27], v[20:23], v[96:111]
    s_add_u32 m0, s38, 50176
    s_nop 0
    buffer_load_dwordx4 v11, s[8:11], s30 offen lds
    v_mfma_f32_32x32x16_bf16 v[112:127], v[28:31], v[20:23], v[112:127]
    ds_read_b128 v[16:19], v14 offset:16384
    ds_read_b128 v[20:23], v14 offset:20480
    ds_read_b64_tr_b16 v[24:25], v8 offset:20480
    ds_read_b64_tr_b16 v[26:27], v8 offset:20992
    ds_read_b64_tr_b16 v[28:29], v8 offset:28672
    ds_read_b64_tr_b16 v[30:31], v8 offset:29184
    s_waitcnt lgkmcnt(6)
    v_mfma_f32_32x32x16_bf16 v[64:79], v[40:43], v[32:35], v[64:79]
    s_add_u32 m0, s38, 51200
    s_nop 0
    buffer_load_dwordx4 v12, s[8:11], s30 offen lds
    v_mfma_f32_32x32x16_bf16 v[80:95], v[44:47], v[32:35], v[80:95]
    v_mfma_f32_32x32x16_bf16 v[96:111], v[40:43], v[36:39], v[96:111]
    s_add_u32 m0, s38, 52224
    s_nop 0
    buffer_load_dwordx4 v13, s[8:11], s30 offen lds
    s_add_u32 s30, s30, 81920
    s_cmp_eq_u32 s30, 983040
    s_cselect_b32 s30, 0, s30
    v_mfma_f32_32x32x16_bf16 v[112:127], v[44:47], v[36:39], v[112:127]
    ds_read_b128 v[32:35], v15 offset:16384
    ds_read_b128 v[36:39], v15 offset:20480
    ds_read_b64_tr_b16 v[40:41], v8 offset:22528
    ds_read_b64_tr_b16 v[42:43], v8 offset:23040
    ds_read_b64_tr_b16 v[44:45], v8 offset:30720
    ds_read_b64_tr_b16 v[46:47], v8 offset:31232
    s_waitcnt lgkmcnt(6)
    v_mfma_f32_32x32x16_bf16 v[64:79], v[24:27], v[16:19], v[64:79]
    s_add_u32 m0, s28, 0
    s_nop 0
    buffer_load_dwordx4 v2, s[4:7], s29 offen lds
    v_mfma_f32_32x32x16_bf16 v[80:95], v[28:31], v[16:19], v[80:95]
    v_mfma_f32_32x32x16_bf16 v[96:111], v[24:27], v[20:23], v[96:111]
    s_add_u32 m0, s28, 1024
    s_nop 0
    buffer_load_dwordx4 v3, s[4:7], s29 offen lds
    v_mfma_f32_32x32x16_bf16 v[112:127], v[28:31], v[20:23], v[112:127]
    s_waitcnt lgkmcnt(0)
    v_mfma_f32_32x32x16_bf16 v[64:79], v[40:43], v[32:35], v[64:79]
    s_add_u32 m0, s28, 2048
    s_nop 0
    buffer_load_dwordx4 v4, s[4:7], s29 offen lds
    v_mfma_f32_32x32x16_bf16 v[80:95], v[44:47], v[32:35], v[80:95]
    v_mfma_f32_32x32x16_bf16 v[96:111], v[40:43], v[36:39], v[96:111]
    s_add_u32 m0, s28, 3072
    s_nop 0
    buffer_load_dwordx4 v5, s[4:7], s29 offen lds
    s_add_u32 s29, s29, 128
    s_cmp_eq_u32 s29, 1536
    s_cselect_b32 s29, 0, s29
    v_mfma_f32_32x32x16_bf16 v[112:127], v[44:47], v[36:39], v[112:127]
    s_waitcnt vmcnt(4)
    s_barrier
    ds_read_b128 v[16:19], v48 offset:0
    ds_read_b128 v[20:23], v48 offset:4096
    ds_read_b64_tr_b16 v[24:25], v8 offset:0
    ds_read_b64_tr_b16 v[26:27], v8 offset:512
    ds_read_b64_tr_b16 v[28:29], v8 offset:8192
    ds_read_b64_tr_b16 v[30:31], v8 offset:8704
    ds_read_b128 v[32:35], v49 offset:0
    ds_read_b128 v[36:39], v49 offset:4096
    ds_read_b64_tr_b16 v[40:41], v8 offset:2048
    ds_read_b64_tr_b16 v[42:43], v8 offset:2560
    ds_read_b64_tr_b16 v[44:45], v8 offset:10240
    ds_read_b64_tr_b16 v[46:47], v8 offset:10752
    s_waitcnt lgkmcnt(6)
    v_mfma_f32_32x32x16_bf16 v[64:79], v[24:27], v[16:19], v[64:79]
    s_add_u32 m0, s38, 65536
    s_nop 0
    buffer_load_dwordx4 v10, s[8:11], s30 offen lds
    v_mfma_f32_32x32x16_bf16 v[80:95], v[28:31], v[16:19], v[80:95]
    v_mfma_f32_32x32x16_bf16 v[96:111], v[24:27], v[20:23], v[96:111]
    s_add_u32 m0, s38, 66560
    s_nop 0
    buffer_load_dwordx4 v11, s[8:11], s30 offen lds
    v_mfma_f32_32x32x16_bf16 v[112:127], v[28:31], v[20:23], v[112:127]
    ds_read_b128 v[16:19], v50 offset:0
    ds_read_b128 v[20:23], v50 offset:4096
    ds_read_b64_tr_b16 v[24:25], v8 offset:4096
    ds_read_b64_tr_b16 v[26:27], v8 offset:4608
    ds_read_b64_tr_b16 v[28:29], v8 offset:12288
    ds_read_b64_tr_b16 v[30:31], v8 offset:12800
    s_waitcnt lgkmcnt(6)
    v_mfma_f32_32x32x16_bf16 v[64:79], v[40:43], v[32:35], v[64:79]
    s_add_u32 m0, s38, 67584
    s_nop 0
    buffer_load_dwordx4 v12, s[8:11], s30 offen lds
    v_mfma_f32_32x32x16_bf16 v[80:95], v[44:47], v[32:35], v[80:95]
    v_mfma_f32_32x32x16_bf16 v[96:111], v[40:43], v[36:39], v[96:111]
    s_add_u32 m0, s38, 68608
    s_nop 0
    buffer_load_dwordx4 v13, s[8:11], s30 offen lds
    s_add_u32 s30, s30, 81920
    s_cmp_eq_u32 s30, 983040
    s_cselect_b32 s30, 0, s30
    v_mfma_f32_32x32x16_bf16 v[112:127], v[44:47], v[36:39], v[112:127]
    ds_read_b128 v[32:35], v51 offset:0
    ds_read_b128 v[36:39], v51 offset:4096
    ds_read_b64_tr_b16 v[40:41], v8 offset:6144
    ds_read_b64_tr_b16 v[42:43], v8 offset:6656
    ds_read_b64_tr_b16 v[44:45], v8 offset:14336
    ds_read_b64_tr_b16 v[46:47], v8 offset:14848
    s_waitcnt lgkmcnt(6)
    v_mfma_f32_32x32x16_bf16 v[64:79], v[24:27], v[16:19], v[64:79]
    s_add_u32 m0, s28, 16384
    s_nop 0
    buffer_load_dwordx4 v2, s[4:7], s29 offen lds
    v_mfma_f32_32x32x16_bf16 v[80:95], v[28:31], v[16:19], v[80:95]
    v_mfma_f32_32x32x16_bf16 v[96:111], v[24:27], v[20:23], v[96:111]
    s_add_u32 m0, s28, 17408
    s_nop 0
    buffer_load_dwordx4 v3, s[4:7], s29 offen lds
    v_mfma_f32_32x32x16_bf16 v[112:127], v[28:31], v[20:23], v[112:127]
    s_waitcnt lgkmcnt(0)
    v_mfma_f32_32x32x16_bf16 v[64:79], v[40:43], v[32:35], v[64:79]
    s_add_u32 m0, s28, 18432
    s_nop 0
    buffer_load_dwordx4 v4, s[4:7], s29 offen lds
    v_mfma_f32_32x32x16_bf16 v[80:95], v[44:47], v[32:35], v[80:95]
    v_mfma_f32_32x32x16_bf16 v[96:111], v[40:43], v[36:39], v[96:111]
    s_add_u32 m0, s28, 19456
    s_nop 0
    buffer_load_dwordx4 v5, s[4:7], s29 offen lds
    s_add_u32 s29, s29, 128
    s_cmp_eq_u32 s29, 1536
    s_cselect_b32 s29, 0, s29
    v_mfma_f32_32x32x16_bf16 v[112:127], v[44:47], v[36:39], v[112:127]
    s_waitcnt vmcnt(4)
    s_barrier
    ds_read_b128 v[16:19], v6 offset:0
    ds_read_b128 v[20:23], v6 offset:4096
    ds_read_b64_tr_b16 v[24:25], v8 offset:16384
    ds_read_b64_tr_b16 v[26:27], v8 offset:16896
    ds_read_b64_tr_b16 v[28:29], v8 offset:24576
    ds_read_b64_tr_b16 v[30:31], v8 offset:25088
    ds_read_b128 v[32:35], v7 offset:0
    ds_read_b128 v[36:39], v7 offset:4096
    ds_read_b64_tr_b16 v[40:41], v8 offset:18432
    ds_read_b64_tr_b16 v[42:43], v8 offset:18944
    ds_read_b64_tr_b16 v[44:45], v8 offset:26624
    ds_read_b64_tr_b16 v[46:47], v8 offset:27136
    s_waitcnt lgkmcnt(6)
    v_mfma_f32_32x32x16_bf16 v[64:79], v[24:27], v[16:19], v[64:79]
    s_add_u32 m0, s38, 49152
    s_nop 0
    buffer_load_dwordx4 v10, s[8:11], s30 offen lds
    v_mfma_f32_32x32x16_bf16 v[80:95], v[28:31], v[16:19], v[80:95]
    v_mfma_f32_32x32x16_bf16 v[96:111], v[24:27], v[20:23], v[96:111]
    s_add_u32 m0, s38, 50176
    s_nop 0
    buffer_load_dwordx4 v11, s[8:11], s30 offen lds
    v_mfma_f32_32x32x16_bf16 v[112:127], v[28:31], v[20:23], v[112:127]
    ds_read_b128 v[16:19], v14 offset:0
    ds_read_b128 v[20:23], v14 offset:4096
    ds_read_b64_tr_b16 v[24:25], v8 offset:20480
    ds_read_b64_tr_b16 v[26:27], v8 offset:20992
    ds_read_b64_tr_b16 v[28:29], v8 offset:28672
    ds_read_b64_tr_b16 v[30:31], v8 offset:29184
    s_waitcnt lgkmcnt(6)
    v_mfma_f32_32x32x16_bf16 v[64:79], v[40:43], v[32:35], v[64:79]
    s_add_u32 m0, s38, 51200
    s_nop 0
    buffer_load_dwordx4 v12, s[8:11], s30 offen lds
    v_mfma_f32_32x32x16_bf16 v[80:95], v[44:47], v[32:35], v[80:95]
    v_mfma_f32_32x32x16_bf16 v[96:111], v[40:43], v[36:39], v[96:111]
    s_add_u32 m0, s38, 52224
    s_nop 0
    buffer_load_dwordx4 v13, s[8:11], s30 offen lds
    s_add_u32 s30, s30, 81920
    s_cmp_eq_u32 s30, 983040
    s_cselect_b32 s30, 0, s30
    v_mfma_f32_32x32x16_bf16 v[112:127], v[44:47], v[36:39], v[112:127]
    ds_read_b128 v[32:35], v15 offset:0
    ds_read_b128 v[36:39], v15 offset:4096
    ds_read_b64_tr_b16 v[40:41], v8 offset:22528
    ds_read_b64_tr_b16 v[42:43], v8 offset:23040
    ds_read_b64_tr_b16 v[44:45], v8 offset:30720
    ds_read_b64_tr_b16 v[46:47], v8 offset:31232
    s_waitcnt lgkmcnt(6)
    v_mfma_f32_32x32x16_bf16 v[64:79], v[24:27], v[16:19], v[64:79]
    s_add_u32 m0, s28, 32768
    s_nop 0
    buffer_load_dwordx4 v2, s[4:7], s29 offen lds
    v_mfma_f32_32x32x16_bf16 v[80:95], v[28:31], v[16:19], v[80:95]
    v_mfma_f32_32x32x16_bf16 v[96:111], v[24:27], v[20:23], v[96:111]
    s_add_u32 m0, s28, 33792
    s_nop 0
    buffer_load_dwordx4 v3, s[4:7], s29 offen lds
    v_mfma_f32_32x32x16_bf16 v[112:127], v[28:31], v[20:23], v[112:127]
    s_waitcnt lgkmcnt(0)
    v_mfma_f32_32x32x16_bf16 v[64:79], v[40:43], v[32:35], v[64:79]
    s_add_u32 m0, s28, 34816
    s_nop 0
    buffer_load_dwordx4 v4, s[4:7], s29 offen lds
    v_mfma_f32_32x32x16_bf16 v[80:95], v[44:47], v[32:35], v[80:95]
    v_mfma_f32_32x32x16_bf16 v[96:111], v[40:43], v[36:39], v[96:111]
    s_add_u32 m0, s28, 35840
    s_nop 0
    buffer_load_dwordx4 v5, s[4:7], s29 offen lds
    s_add_u32 s29, s29, 128
    s_cmp_eq_u32 s29, 1536
    s_cselect_b32 s29, 0, s29
    v_mfma_f32_32x32x16_bf16 v[112:127], v[44:47], v[36:39], v[112:127]
    s_waitcnt vmcnt(4)
    s_barrier
    ds_read_b128 v[16:19], v6 offset:16384
    ds_read_b128 v[20:23], v6 offset:20480
    ds_read_b64_tr_b16 v[24:25], v8 offset:0
    ds_read_b64_tr_b16 v[26:27], v8 offset:512
    ds_read_b64_tr_b16 v[28:29], v8 offset:8192
    ds_read_b64_tr_b16 v[30:31], v8 offset:8704
    ds_read_b128 v[32:35], v7 offset:16384
    ds_read_b128 v[36:39], v7 offset:20480
    ds_read_b64_tr_b16 v[40:41], v8 offset:2048
    ds_read_b64_tr_b16 v[42:43], v8 offset:2560
    ds_read_b64_tr_b16 v[44:45], v8 offset:10240
    ds_read_b64_tr_b16 v[46:47], v8 offset:10752
    s_waitcnt lgkmcnt(6)
    v_mfma_f32_32x32x16_bf16 v[64:79], v[24:27], v[16:19], v[64:79]
    s_add_u32 m0, s38, 65536
    s_nop 0
    buffer_load_dwordx4 v10, s[8:11], s30 offen lds
    v_mfma_f32_32x32x16_bf16 v[80:95], v[28:31], v[16:19], v[80:95]
    v_mfma_f32_32x32x16_bf16 v[96:111], v[24:27], v[20:23], v[96:111]
    s_add_u32 m0, s38, 66560
    s_nop 0
    buffer_load_dwordx4 v11, s[8:11], s30 offen lds
    v_mfma_f32_32x32x16_bf16 v[112:127], v[28:31], v[20:23], v[112:127]
    ds_read_b128 v[16:19], v14 offset:16384
    ds_read_b128 v[20:23], v14 offset:20480
    ds_read_b64_tr_b16 v[24:25], v8 offset:4096
    ds_read_b64_tr_b16 v[26:27], v8 offset:4608
    ds_read_b64_tr_b16 v[28:29], v8 offset:12288
    ds_read_b64_tr_b16 v[30:31], v8 offset:12800
    s_waitcnt lgkmcnt(6)
    v_mfma_f32_32x32x16_bf16 v[64:79], v[40:43], v[32:35], v[64:79]
    s_add_u32 m0, s38, 67584
    s_nop 0
    buffer_load_dwordx4 v12, s[8:11], s30 offen lds
    v_mfma_f32_32x32x16_bf16 v[80:95], v[44:47], v[32:35], v[80:95]
    v_mfma_f32_32x32x16_bf16 v[96:111], v[40:43], v[36:39], v[96:111]
    s_add_u32 m0, s38, 68608
    s_nop 0
    buffer_load_dwordx4 v13, s[8:11], s30 offen lds
    s_add_u32 s30, s30, 81920
    s_cmp_eq_u32 s30, 983040
    s_cselect_b32 s30, 0, s30
    v_mfma_f32_32x32x16_bf16 v[112:127], v[44:47], v[36:39], v[112:127]
    ds_read_b128 v[32:35], v15 offset:16384
    ds_read_b128 v[36:39], v15 offset:20480
    ds_read_b64_tr_b16 v[40:41], v8 offset:6144
    ds_read_b64_tr_b16 v[42:43], v8 offset:6656
    ds_read_b64_tr_b16 v[44:45], v8 offset:14336
    ds_read_b64_tr_b16 v[46:47], v8 offset:14848
    s_waitcnt lgkmcnt(6)
    v_mfma_f32_32x32x16_bf16 v[64:79], v[24:27], v[16:19], v[64:79]
    v_mfma_f32_32x32x16_bf16 v[80:95], v[28:31], v[16:19], v[80:95]
    v_mfma_f32_32x32x16_bf16 v[96:111], v[24:27], v[20:23], v[96:111]
    v_mfma_f32_32x32x16_bf16 v[112:127], v[28:31], v[20:23], v[112:127]
    s_waitcnt lgkmcnt(0)
    v_mfma_f32_32x32x16_bf16 v[64:79], v[40:43], v[32:35], v[64:79]
    v_mfma_f32_32x32x16_bf16 v[80:95], v[44:47], v[32:35], v[80:95]
    v_mfma_f32_32x32x16_bf16 v[96:111], v[40:43], v[36:39], v[96:111]
    v_mfma_f32_32x32x16_bf16 v[112:127], v[44:47], v[36:39], v[112:127]
    s_waitcnt vmcnt(0)
    s_barrier
    ds_read_b128 v[16:19], v48 offset:0
    ds_read_b128 v[20:23], v48 offset:4096
    ds_read_b64_tr_b16 v[24:25], v8 offset:16384
    ds_read_b64_tr_b16 v[26:27], v8 offset:16896
    ds_read_b64_tr_b16 v[28:29], v8 offset:24576
    ds_read_b64_tr_b16 v[30:31], v8 offset:25088
    ds_read_b128 v[32:35], v49 offset:0
    ds_read_b128 v[36:39], v49 offset:4096
    ds_read_b64_tr_b16 v[40:41], v8 offset:18432
    ds_read_b64_tr_b16 v[42:43], v8 offset:18944
    ds_read_b64_tr_b16 v[44:45], v8 offset:26624
    ds_read_b64_tr_b16 v[46:47], v8 offset:27136
    s_waitcnt lgkmcnt(6)
    v_mfma_f32_32x32x16_bf16 v[64:79], v[24:27], v[16:19], v[64:79]
    v_mfma_f32_32x32x16_bf16 v[80:95], v[28:31], v[16:19], v[80:95]
    v_mfma_f32_32x32x16_bf16 v[96:111], v[24:27], v[20:23], v[96:111]
    v_mfma_f32_32x32x16_bf16 v[112:127], v[28:31], v[20:23], v[112:127]
    ds_read_b128 v[16:19], v50 offset:0
    ds_read_b128 v[20:23], v50 offset:4096
    ds_read_b64_tr_b16 v[24:25], v8 offset:20480
    ds_read_b64_tr_b16 v[26:27], v8 offset:20992
    ds_read_b64_tr_b16 v[28:29], v8 offset:28672
    ds_read_b64_tr_b16 v[30:31], v8 offset:29184
    s_waitcnt lgkmcnt(6)
    v_mfma_f32_32x32x16_bf16 v[64:79], v[40:43], v[32:35], v[64:79]
    v_mfma_f32_32x32x16_bf16 v[80:95], v[44:47], v[32:35], v[80:95]
    v_mfma_f32_32x32x16_bf16 v[96:111], v[40:43], v[36:39], v[96:111]
    v_mfma_f32_32x32x16_bf16 v[112:127], v[44:47], v[36:39], v[112:127]
    ds_read_b128 v[32:35], v51 offset:0
    ds_read_b128 v[36:39], v51 offset:4096
    ds_read_b64_tr_b16 v[40:41], v8 offset:22528
    ds_read_b64_tr_b16 v[42:43], v8 offset:23040
    ds_read_b64_tr_b16 v[44:45], v8 offset:30720
    ds_read_b64_tr_b16 v[46:47], v8 offset:31232
    s_waitcnt lgkmcnt(6)
    v_mfma_f32_32x32x16_bf16 v[64:79], v[24:27], v[16:19], v[64:79]
    v_mfma_f32_32x32x16_bf16 v[80:95], v[28:31], v[16:19], v[80:95]
    v_mfma_f32_32x32x16_bf16 v[96:111], v[24:27], v[20:23], v[96:111]
    v_mfma_f32_32x32x16_bf16 v[112:127], v[28:31], v[20:23], v[112:127]
    s_waitcnt lgkmcnt(0)
    v_mfma_f32_32x32x16_bf16 v[64:79], v[40:43], v[32:35], v[64:79]
    v_mfma_f32_32x32x16_bf16 v[80:95], v[44:47], v[32:35], v[80:95]
    v_mfma_f32_32x32x16_bf16 v[96:111], v[40:43], v[36:39], v[96:111]
    v_mfma_f32_32x32x16_bf16 v[112:127], v[44:47], v[36:39], v[112:127]
    s_nop 7
    s_nop 7
    s_add_u32 s16, s98, 12582912
    s_addc_u32 s17, s99, 0
    s_mov_b32 s18, 7864320
    s_mov_b32 s19, 0x00020000
    s_and_b32 s26, s20, 1
    s_lshl_b32 s26, s26, 6
    v_and_b32 v1, 31, v0
    v_add_u32 v1, s26, v1
    v_lshlrev_b32 v2, 7, v1
    s_lshr_b32 s26, s20, 1
    s_lshl_b32 s26, s26, 2
    v_lshrrev_b32 v1, 5, v0
    v_add_u32 v1, s26, v1
    v_and_b32 v3, 7, v0
    v_xor_b32 v1, v1, v3
    v_lshl_add_u32 v2, v1, 4, v2
    v_xor_b32 v3, 32, v2
    s_lshl_b32 s26, s20, 5
    s_add_u32 s26, s26, s21
    v_lshrrev_b32 v1, 3, v0
    v_add_u32 v4, s26, v1
    v_mul_u32_u24 v4, 1280, v4
    v_xor_b32 v1, v1, v0
    v_and_b32 v1, 7, v1
    v_lshl_add_u32 v4, v1, 4, v4
    s_mul_i32 s27, s31, 2621440
    s_add_u32 s26, s22, s27
    v_add_u32 v4, s26, v4
    s_lshl_b32 s26, s20, 12
    v_lshlrev_b32 v5, 4, v0
    v_add_u32 v5, s26, v5
    s_barrier
    v_cvt_pk_bf16_f32 v16, v64, v65
    v_cvt_pk_bf16_f32 v17, v66, v67
    v_cvt_pk_bf16_f32 v18, v68, v69
    v_cvt_pk_bf16_f32 v19, v70, v71
    ds_write_b128 v2, v[16:19] offset:0
    v_cvt_pk_bf16_f32 v20, v72, v73
    v_cvt_pk_bf16_f32 v21, v74, v75
    v_cvt_pk_bf16_f32 v22, v76, v77
    v_cvt_pk_bf16_f32 v23, v78, v79
    ds_write_b128 v3, v[20:23] offset:0
    v_cvt_pk_bf16_f32 v24, v80, v81
    v_cvt_pk_bf16_f32 v25, v82, v83
    v_cvt_pk_bf16_f32 v26, v84, v85
    v_cvt_pk_bf16_f32 v27, v86, v87
    ds_write_b128 v2, v[24:27] offset:16384
    v_cvt_pk_bf16_f32 v28, v88, v89
    v_cvt_pk_bf16_f32 v29, v90, v91
    v_cvt_pk_bf16_f32 v30, v92, v93
    v_cvt_pk_bf16_f32 v31, v94, v95
    ds_write_b128 v3, v[28:31] offset:16384
    v_cvt_pk_bf16_f32 v32, v96, v97
    v_cvt_pk_bf16_f32 v33, v98, v99
    v_cvt_pk_bf16_f32 v34, v100, v101
    v_cvt_pk_bf16_f32 v35, v102, v103
    ds_write_b128 v2, v[32:35] offset:4096
    v_cvt_pk_bf16_f32 v36, v104, v105
    v_cvt_pk_bf16_f32 v37, v106, v107
    v_cvt_pk_bf16_f32 v38, v108, v109
    v_cvt_pk_bf16_f32 v39, v110, v111
    ds_write_b128 v3, v[36:39] offset:4096
    v_cvt_pk_bf16_f32 v40, v112, v113
    v_cvt_pk_bf16_f32 v41, v114, v115
    v_cvt_pk_bf16_f32 v42, v116, v117
    v_cvt_pk_bf16_f32 v43, v118, v119
    ds_write_b128 v2, v[40:43] offset:20480
    v_cvt_pk_bf16_f32 v44, v120, v121
    v_cvt_pk_bf16_f32 v45, v122, v123
    v_cvt_pk_bf16_f32 v46, v124, v125
    v_cvt_pk_bf16_f32 v47, v126, v127
    ds_write_b128 v3, v[44:47] offset:20480
    s_waitcnt lgkmcnt(0)
    s_barrier
    ds_read_b128 v[64:67], v5 offset:0
    ds_read_b128 v[68:71], v5 offset:1024
    ds_read_b128 v[72:75], v5 offset:2048
    ds_read_b128 v[76:79], v5 offset:3072
    ds_read_b128 v[80:83], v5 offset:16384
    ds_read_b128 v[84:87], v5 offset:17408
    ds_read_b128 v[88:91], v5 offset:18432
    ds_read_b128 v[92:95], v5 offset:19456
    s_waitcnt lgkmcnt(7)
    s_mov_b32 s26, 0
    buffer_store_dwordx4 v[64:67], v4, s[16:19], s26 offen offset:0 sc1
    s_waitcnt lgkmcnt(6)
    s_mov_b32 s26, 10240
    buffer_store_dwordx4 v[68:71], v4, s[16:19], s26 offen offset:0 sc1
    s_waitcnt lgkmcnt(5)
    s_mov_b32 s26, 20480
    buffer_store_dwordx4 v[72:75], v4, s[16:19], s26 offen offset:0 sc1
    s_waitcnt lgkmcnt(4)
    s_mov_b32 s26, 30720
    buffer_store_dwordx4 v[76:79], v4, s[16:19], s26 offen offset:0 sc1
    s_waitcnt lgkmcnt(3)
    s_mov_b32 s26, 0
    buffer_store_dwordx4 v[80:83], v4, s[16:19], s26 offen offset:128 sc1
    s_waitcnt lgkmcnt(2)
    s_mov_b32 s26, 10240
    buffer_store_dwordx4 v[84:87], v4, s[16:19], s26 offen offset:128 sc1
    s_waitcnt lgkmcnt(1)
    s_mov_b32 s26, 20480
    buffer_store_dwordx4 v[88:91], v4, s[16:19], s26 offen offset:128 sc1
    s_waitcnt lgkmcnt(0)
    s_mov_b32 s26, 30720
    buffer_store_dwordx4 v[92:95], v4, s[16:19], s26 offen offset:128 sc1
    s_mov_b32 s4, s72
    s_mov_b32 s5, s73
    s_mov_b32 s6, 819200
    s_mov_b32 s7, 0x00020000
    s_lshr_b32 s26, s3, 3
    s_lshl_b32 s26, s26, 2
    s_add_u32 s26, s26, s20
    s_mul_i32 s26, s26, 10240
    v_add_u32 v1, 0, v0
    v_min_u32 v1, 79, v1
    v_lshlrev_b32 v1, 7, v1
    buffer_load_dword v8, v1, s[4:7], s26 offen
    v_add_u32 v1, 64, v0
    v_min_u32 v1, 79, v1
    v_lshlrev_b32 v1, 7, v1
    buffer_load_dword v9, v1, s[4:7], s26 offen
La_end:
    s_endpgm
.globl out_kernel
.p2align 8
.type out_kernel,@function
out_kernel:
    s_cmp_ge_u32 s2, 240
    s_cbranch_scc1 Lo_end
    s_lshr_b32 s26, s2, 3
    s_cmp_ge_u32 s26, 10
    s_cselect_b32 s27, 1, 0
    s_cmp_ge_u32 s26, 20
    s_cselect_b32 s27, 2, s27
    s_mul_i32 s21, s27, 10
    s_sub_u32 s26, s26, s21
    s_lshl_b32 s21, s27, 3
    s_and_b32 s22, s2, 7
    s_add_u32 s21, s21, s22
    s_cmp_ge_u32 s21, 22
    s_cbranch_scc1 Lo_end
    s_load_dwordx2 s[98:99], s[0:1], 96
    s_load_dwordx16 s[64:79], s[0:1], 0
    s_load_dwordx8 s[80:87], s[0:1], 64
    v_lshrrev_b32 v1, 6, v0
    v_and_b32 v0, 63, v0
    s_nop 0
    v_readfirstlane_b32 s20, v1
    s_mul_i32 s21, s21, 96
    s_lshl_b32 s22, s26, 7
    s_mul_i32 s27, s27, 3
    s_add_u32 s35, s26, s27
    s_cmp_ge_u32 s35, 10
    s_cselect_b32 s27, 10, 0
    s_sub_u32 s35, s35, s27
    s_lshl_b32 s26, s20, 5
    s_add_u32 s26, s26, s21
    v_lshrrev_b32 v1, 3, v0
    v_add_u32 v1, s26, v1
    v_mul_u32_u24 v2, 1280, v1
    v_lshrrev_b32 v1, 4, v0
    v_xor_b32 v1, v1, v0
    v_and_b32 v1, 7, v1
    v_xor_b32 v9, 4, v1
    v_add_u32 v3, 10240, v2
    v_lshl_add_u32 v2, v1, 4, v2
    v_lshl_add_u32 v3, v9, 4, v3
    v_add_u32 v4, 20480, v2
    v_add_u32 v5, 20480, v3
    s_mul_i32 s26, s20, 24
    v_lshrrev_b32 v1, 3, v0
    v_add_u32 v1, s26, v1
    v_mul_u32_u24 v10, 1280, v1
    v_lshrrev_b32 v1, 2, v0
    v_and_b32 v1, 4, v1
    v_xor_b32 v1, v1, v0
    v_and_b32 v1, 7, v1
    v_lshl_add_u32 v10, v1, 4, v10
    v_add_u32 v10, s22, v10
    v_add_u32 v11, 10240, v10
    s_cmp_eq_u32 s20, 2
    s_cselect_b32 s26, 61440, 0
    s_cselect_b32 s27, 0, 20480
    v_subrev_u32 v247, s26, v10
    v_add_u32 v247, s27, v247
    s_lshl_b32 s28, s20, 12
    s_mul_i32 s31, s20, 3072
    s_add_u32 s41, s31, 2048
    s_cmp_eq_u32 s20, 2
    s_cselect_b32 s41, 0, s41
    s_lshl_b32 s29, s35, 7
    s_mul_i32 s30, s35, 81920
    s_waitcnt lgkmcnt(0)
    s_mov_b32 s8, s72
    s_mov_b32 s9, s73
    s_mov_b32 s10, 819200
    s_mov_b32 s11, 0x00020000
    s_mov_b32 s16, s84
    s_mov_b32 s17, s85
    s_mov_b32 s18, 2621440
    s_mov_b32 s19, 0x00020000
    s_add_u32 s4, s98, 9437184
    s_addc_u32 s5, s99, 0
    s_mov_b32 s6, 2621440
    s_mov_b32 s7, 0x00020000
    s_add_u32 m0, s28, 0
    s_nop 0
    buffer_load_dwordx4 v2, s[4:7], s29 offen lds
    s_add_u32 m0, s28, 1024
    s_nop 0
    buffer_load_dwordx4 v3, s[4:7], s29 offen lds
    s_add_u32 m0, s28, 2048
    s_nop 0
    buffer_load_dwordx4 v4, s[4:7], s29 offen lds
    s_add_u32 m0, s28, 3072
    s_nop 0
    buffer_load_dwordx4 v5, s[4:7], s29 offen lds
    s_add_u32 m0, s31, 16384
    s_nop 0
    buffer_load_dwordx4 v10, s[8:11], s30 offen lds
    s_add_u32 m0, s31, 17408
    s_nop 0
    buffer_load_dwordx4 v11, s[8:11], s30 offen lds
    s_add_u32 m0, s41, 16384
    s_nop 0
    buffer_load_dwordx4 v247, s[8:11], s30 offen lds
    s_add_u32 s29, s29, 128
    s_add_u32 s30, s30, 81920
    s_cmp_eq_u32 s29, 1280
    s_cselect_b32 s29, 0, s29
    s_cselect_b32 s30, 0, s30
    s_add_u32 m0, s28, 24576
    s_nop 0
    buffer_load_dwordx4 v2, s[4:7], s29 offen lds
    s_add_u32 m0, s28, 25600
    s_nop 0
    buffer_load_dwordx4 v3, s[4:7], s29 offen lds
    s_add_u32 m0, s28, 26624
    s_nop 0
    buffer_load_dwordx4 v4, s[4:7], s29 offen lds
    s_add_u32 m0, s28, 27648
    s_nop 0
    buffer_load_dwordx4 v5, s[4:7], s29 offen lds
    s_add_u32 m0, s31, 40960
    s_nop 0
    buffer_load_dwordx4 v10, s[8:11], s30 offen lds
    s_add_u32 m0, s31, 41984
    s_nop 0
    buffer_load_dwordx4 v11, s[8:11], s30 offen lds
    s_add_u32 m0, s41, 40960
    s_nop 0
    buffer_load_dwordx4 v247, s[8:11], s30 offen lds
    s_add_u32 s29, s29, 128
    s_add_u32 s30, s30, 81920
    s_cmp_eq_u32 s29, 1280
    s_cselect_b32 s29, 0, s29
    s_cselect_b32 s30, 0, s30
    s_add_u32 m0, s28, 49152
    s_nop 0
    buffer_load_dwordx4 v2, s[4:7], s29 offen lds
    s_add_u32 m0, s28, 50176
    s_nop 0
    buffer_load_dwordx4 v3, s[4:7], s29 offen lds
    s_add_u32 m0, s28, 51200
    s_nop 0
    buffer_load_dwordx4 v4, s[4:7], s29 offen lds
    s_add_u32 m0, s28, 52224
    s_nop 0
    buffer_load_dwordx4 v5, s[4:7], s29 offen lds
    s_add_u32 m0, s31, 65536
    s_nop 0
    buffer_load_dwordx4 v10, s[8:11], s30 offen lds
    s_add_u32 m0, s31, 66560
    s_nop 0
    buffer_load_dwordx4 v11, s[8:11], s30 offen lds
    s_add_u32 m0, s41, 65536
    s_nop 0
    buffer_load_dwordx4 v247, s[8:11], s30 offen lds
    s_add_u32 s29, s29, 128
    s_add_u32 s30, s30, 81920
    s_cmp_eq_u32 s29, 1280
    s_cselect_b32 s29, 0, s29
    s_cselect_b32 s30, 0, s30
    s_add_u32 m0, s28, 73728
    s_nop 0
    buffer_load_dwordx4 v2, s[4:7], s29 offen lds
    s_add_u32 m0, s28, 74752
    s_nop 0
    buffer_load_dwordx4 v3, s[4:7], s29 offen lds
    s_add_u32 m0, s28, 75776
    s_nop 0
    buffer_load_dwordx4 v4, s[4:7], s29 offen lds
    s_add_u32 m0, s28, 76800
    s_nop 0
    buffer_load_dwordx4 v5, s[4:7], s29 offen lds
    s_add_u32 m0, s31, 90112
    s_nop 0
    buffer_load_dwordx4 v10, s[8:11], s30 offen lds
    s_add_u32 m0, s31, 91136
    s_nop 0
    buffer_load_dwordx4 v11, s[8:11], s30 offen lds
    s_add_u32 m0, s41, 90112
    s_nop 0
    buffer_load_dwordx4 v247, s[8:11], s30 offen lds
    s_add_u32 s29, s29, 128
    s_add_u32 s30, s30, 81920
    s_cmp_eq_u32 s29, 1280
    s_cselect_b32 s29, 0, s29
    s_cselect_b32 s30, 0, s30
    s_add_u32 m0, s28, 98304
    s_nop 0
    buffer_load_dwordx4 v2, s[4:7], s29 offen lds
    s_add_u32 m0, s28, 99328
    s_nop 0
    buffer_load_dwordx4 v3, s[4:7], s29 offen lds
    s_add_u32 m0, s28, 100352
    s_nop 0
    buffer_load_dwordx4 v4, s[4:7], s29 offen lds
    s_add_u32 m0, s28, 101376
    s_nop 0
    buffer_load_dwordx4 v5, s[4:7], s29 offen lds
    s_add_u32 m0, s31, 114688
    s_nop 0
    buffer_load_dwordx4 v10, s[8:11], s30 offen lds
    s_add_u32 m0, s31, 115712
    s_nop 0
    buffer_load_dwordx4 v11, s[8:11], s30 offen lds
    s_add_u32 m0, s41, 114688
    s_nop 0
    buffer_load_dwordx4 v247, s[8:11], s30 offen lds
    s_add_u32 s29, s29, 128
    s_add_u32 s30, s30, 81920
    s_cmp_eq_u32 s29, 1280
    s_cselect_b32 s29, 0, s29
    s_cselect_b32 s30, 0, s30
    s_add_u32 s12, s98, 12582912
    s_addc_u32 s13, s99, 0
    s_mov_b32 s14, 7864320
    s_mov_b32 s15, 0x00020000
    s_add_u32 s36, s98, 9109504
    s_addc_u32 s37, s99, 0
    s_mov_b32 s38, 8192
    s_mov_b32 s39, 0x00020000
    s_lshl_b32 s26, s20, 5
    s_add_u32 s26, s26, s21
    v_and_b32 v1, 31, v0
    v_add_u32 v12, s26, v1
    v_lshrrev_b32 v9, 5, v0
    v_mul_u32_u24 v15, 1280, v12
    v_lshl_add_u32 v15, v9, 4, v15
    v_add_u32 v15, s22, v15
    v_lshlrev_b32 v12, 2, v12
    s_lshl_b32 s26, s20, 5
    v_and_b32 v1, 31, v0
    v_add_u32 v1, s26, v1
    v_lshlrev_b32 v6, 7, v1
    v_bfe_u32 v1, v0, 1, 3
    v_xor_b32 v1, v1, v9
    v_lshl_add_u32 v6, v1, 4, v6
    v_lshlrev_b32 v1, 3, v9
    v_bfe_u32 v7, v0, 2, 2
    v_add_u32 v1, v1, v7
    v_lshlrev_b32 v7, 7, v1
    v_and_b32 v1, 1, v0
    v_lshlrev_b32 v1, 1, v1
    v_bfe_u32 v8, v0, 1, 1
    v_or_b32 v1, v1, v8
    v_lshlrev_b32 v1, 3, v1
    v_bfe_u32 v8, v0, 4, 1
    v_lshl_add_u32 v1, v8, 5, v1
    v_bfe_u32 v8, v0, 3, 1
    v_lshlrev_b32 v8, 6, v8
    v_xor_b32 v1, v1, v8
    v_add_u32 v7, v7, v1
    v_add_u32 v7, 16384, v7
    v_xor_b32 v8, 64, v7
    v_add_u32 v245, 49152, v7
    v_add_u32 v246, 49152, v8
    v_add_u32 v248, 98304, v7
    v_add_u32 v249, 98304, v8
    v_xor_b32 v232, 0, v6
    v_add_u32 v236, 49152, v232
    v_add_u32 v240, 98304, v232
    v_xor_b32 v233, 32, v6
    v_add_u32 v237, 49152, v233
    v_add_u32 v241, 98304, v233
    v_xor_b32 v234, 64, v6
    v_add_u32 v238, 49152, v234
    v_add_u32 v242, 98304, v234
    v_xor_b32 v235, 96, v6
    v_add_u32 v239, 49152, v235
    v_add_u32 v243, 98304, v235
    s_lshl_b32 s26, s20, 5
    s_add_u32 s26, s26, s21
    v_lshrrev_b32 v1, 3, v0
    v_add_u32 v250, s26, v1
    v_mul_u32_u24 v250, 1280, v250
    v_xor_b32 v1, v1, v0
    v_and_b32 v1, 7, v1
    v_lshl_add_u32 v250, v1, 4, v250
    v_add_u32 v250, s22, v250
    s_mul_i32 s33, s20, 12288
    s_add_u32 s33, s33, 98304
    v_and_b32 v1, 31, v0
    v_lshlrev_b32 v251, 7, v1
    v_and_b32 v1, 7, v0
    v_xor_b32 v1, v1, v9
    v_lshl_add_u32 v251, v1, 4, v251
    v_add_u32 v251, s33, v251
    v_mov_b32 v64, 0
    v_mov_b32 v65, 0
    v_mov_b32 v66, 0
    v_mov_b32 v67, 0
    v_mov_b32 v68, 0
    v_mov_b32 v69, 0
    v_mov_b32 v70, 0
    v_mov_b32 v71, 0
    v_mov_b32 v72, 0
    v_mov_b32 v73, 0
    v_mov_b32 v74, 0
    v_mov_b32 v75, 0
    v_mov_b32 v76, 0
    v_mov_b32 v77, 0
    v_mov_b32 v78, 0
    v_mov_b32 v79, 0
    v_mov_b32 v80, 0
    v_mov_b32 v81, 0
    v_mov_b32 v82, 0
    v_mov_b32 v83, 0
    v_mov_b32 v84, 0
    v_mov_b32 v85, 0
    v_mov_b32 v86, 0
    v_mov_b32 v87, 0
    v_mov_b32 v88, 0
    v_mov_b32 v89, 0
    v_mov_b32 v90, 0
    v_mov_b32 v91, 0
    v_mov_b32 v92, 0
    v_mov_b32 v93, 0
    v_mov_b32 v94, 0
    v_mov_b32 v95, 0
    s_waitcnt vmcnt(28)
    s_barrier
    s_add_u32 m0, s28, 122880
    s_nop 0
    buffer_load_dwordx4 v2, s[4:7], s29 offen lds
    s_add_u32 m0, s28, 123904
    s_nop 0
    buffer_load_dwordx4 v3, s[4:7], s29 offen lds
    s_add_u32 m0, s28, 124928
    s_nop 0
    buffer_load_dwordx4 v4, s[4:7], s29 offen lds
    s_add_u32 m0, s28, 125952
    s_nop 0
    buffer_load_dwordx4 v5, s[4:7], s29 offen lds
    s_add_u32 m0, s31, 139264
    s_nop 0
    buffer_load_dwordx4 v10, s[8:11], s30 offen lds
    s_add_u32 m0, s31, 140288
    s_nop 0
    buffer_load_dwordx4 v11, s[8:11], s30 offen lds
    s_add_u32 m0, s41, 139264
    s_nop 0
    buffer_load_dwordx4 v247, s[8:11], s30 offen lds
    s_add_u32 s29, s29, 128
    s_add_u32 s30, s30, 81920
    s_cmp_eq_u32 s29, 1280
    s_cselect_b32 s29, 0, s29
    s_cselect_b32 s30, 0, s30
    ds_read_b128 v[96:99], v232 offset:0
    ds_read_b64_tr_b16 v[100:101], v7 offset:0
    ds_read_b64_tr_b16 v[102:103], v7 offset:512
    ds_read_b64_tr_b16 v[104:105], v8 offset:0
    ds_read_b64_tr_b16 v[106:107], v8 offset:512
    ds_read_b128 v[108:111], v233 offset:0
    ds_read_b64_tr_b16 v[112:113], v7 offset:2048
    ds_read_b64_tr_b16 v[114:115], v7 offset:2560
    ds_read_b64_tr_b16 v[116:117], v8 offset:2048
    ds_read_b64_tr_b16 v[118:119], v8 offset:2560
    ds_read_b128 v[120:123], v234 offset:0
    ds_read_b64_tr_b16 v[124:125], v7 offset:4096
    ds_read_b64_tr_b16 v[126:127], v7 offset:4608
    ds_read_b64_tr_b16 v[128:129], v8 offset:4096
    ds_read_b64_tr_b16 v[130:131], v8 offset:4608
    ds_read_b128 v[132:135], v235 offset:0
    ds_read_b64_tr_b16 v[136:137], v7 offset:6144
    ds_read_b64_tr_b16 v[138:139], v7 offset:6656
    ds_read_b64_tr_b16 v[140:141], v8 offset:6144
    ds_read_b64_tr_b16 v[142:143], v8 offset:6656
    s_waitcnt lgkmcnt(15)
    v_mfma_f32_32x32x16_bf16 v[64:79], v[100:103], v[96:99], v[64:79]
    v_mfma_f32_32x32x16_bf16 v[80:95], v[104:107], v[96:99], v[80:95]
    s_waitcnt lgkmcnt(10)
    v_mfma_f32_32x32x16_bf16 v[64:79], v[112:115], v[108:111], v[64:79]
    v_mfma_f32_32x32x16_bf16 v[80:95], v[116:119], v[108:111], v[80:95]
    s_waitcnt lgkmcnt(5)
    v_mfma_f32_32x32x16_bf16 v[64:79], v[124:127], v[120:123], v[64:79]
    v_mfma_f32_32x32x16_bf16 v[80:95], v[128:131], v[120:123], v[80:95]
    s_waitcnt lgkmcnt(0)
    v_mfma_f32_32x32x16_bf16 v[64:79], v[136:139], v[132:135], v[64:79]
    v_mfma_f32_32x32x16_bf16 v[80:95], v[140:143], v[132:135], v[80:95]
    s_waitcnt vmcnt(28)
    s_barrier
    s_add_u32 m0, s28, 0
    s_nop 0
    buffer_load_dwordx4 v2, s[4:7], s29 offen lds
    s_add_u32 m0, s28, 1024
    s_nop 0
    buffer_load_dwordx4 v3, s[4:7], s29 offen lds
    s_add_u32 m0, s28, 2048
    s_nop 0
    buffer_load_dwordx4 v4, s[4:7], s29 offen lds
    s_add_u32 m0, s28, 3072
    s_nop 0
    buffer_load_dwordx4 v5, s[4:7], s29 offen lds
    s_add_u32 m0, s31, 16384
    s_nop 0
    buffer_load_dwordx4 v10, s[8:11], s30 offen lds
    s_add_u32 m0, s31, 17408
    s_nop 0
    buffer_load_dwordx4 v11, s[8:11], s30 offen lds
    s_add_u32 m0, s41, 16384
    s_nop 0
    buffer_load_dwordx4 v247, s[8:11], s30 offen lds
    s_add_u32 s29, s29, 128
    s_add_u32 s30, s30, 81920
    s_cmp_eq_u32 s29, 1280
    s_cselect_b32 s29, 0, s29
    s_cselect_b32 s30, 0, s30
    ds_read_b128 v[144:147], v232 offset:24576
    ds_read_b64_tr_b16 v[148:149], v7 offset:24576
    ds_read_b64_tr_b16 v[150:151], v7 offset:25088
    ds_read_b64_tr_b16 v[152:153], v8 offset:24576
    ds_read_b64_tr_b16 v[154:155], v8 offset:25088
    ds_read_b128 v[156:159], v233 offset:24576
    ds_read_b64_tr_b16 v[160:161], v7 offset:26624
    ds_read_b64_tr_b16 v[162:163], v7 offset:27136
    ds_read_b64_tr_b16 v[164:165], v8 offset:26624
    ds_read_b64_tr_b16 v[166:167], v8 offset:27136
    ds_read_b128 v[168:171], v234 offset:24576
    ds_read_b64_tr_b16 v[172:173], v7 offset:28672
    ds_read_b64_tr_b16 v[174:175], v7 offset:29184
    ds_read_b64_tr_b16 v[176:177], v8 offset:28672
    ds_read_b64_tr_b16 v[178:179], v8 offset:29184
    ds_read_b128 v[180:183], v235 offset:24576
    ds_read_b64_tr_b16 v[184:185], v7 offset:30720
    ds_read_b64_tr_b16 v[186:187], v7 offset:31232
    ds_read_b64_tr_b16 v[188:189], v8 offset:30720
    ds_read_b64_tr_b16 v[190:191], v8 offset:31232
    s_waitcnt lgkmcnt(15)
    v_mfma_f32_32x32x16_bf16 v[64:79], v[148:151], v[144:147], v[64:79]
    v_mfma_f32_32x32x16_bf16 v[80:95], v[152:155], v[144:147], v[80:95]
    s_waitcnt lgkmcnt(10)
    v_mfma_f32_32x32x16_bf16 v[64:79], v[160:163], v[156:159], v[64:79]
    v_mfma_f32_32x32x16_bf16 v[80:95], v[164:167], v[156:159], v[80:95]
    s_waitcnt lgkmcnt(5)
    v_mfma_f32_32x32x16_bf16 v[64:79], v[172:175], v[168:171], v[64:79]
    v_mfma_f32_32x32x16_bf16 v[80:95], v[176:179], v[168:171], v[80:95]
    s_waitcnt lgkmcnt(0)
    v_mfma_f32_32x32x16_bf16 v[64:79], v[184:187], v[180:183], v[64:79]
    v_mfma_f32_32x32x16_bf16 v[80:95], v[188:191], v[180:183], v[80:95]
    s_waitcnt vmcnt(28)
    s_barrier
    s_add_u32 m0, s28, 24576
    s_nop 0
    buffer_load_dwordx4 v2, s[4:7], s29 offen lds
    s_add_u32 m0, s28, 25600
    s_nop 0
    buffer_load_dwordx4 v3, s[4:7], s29 offen lds
    s_add_u32 m0, s28, 26624
    s_nop 0
    buffer_load_dwordx4 v4, s[4:7], s29 offen lds
    s_add_u32 m0, s28, 27648
    s_nop 0
    buffer_load_dwordx4 v5, s[4:7], s29 offen lds
    s_add_u32 m0, s31, 40960
    s_nop 0
    buffer_load_dwordx4 v10, s[8:11], s30 offen lds
    s_add_u32 m0, s31, 41984
    s_nop 0
    buffer_load_dwordx4 v11, s[8:11], s30 offen lds
    s_add_u32 m0, s41, 40960
    s_nop 0
    buffer_load_dwordx4 v247, s[8:11], s30 offen lds
    s_add_u32 s29, s29, 128
    s_add_u32 s30, s30, 81920
    s_cmp_eq_u32 s29, 1280
    s_cselect_b32 s29, 0, s29
    s_cselect_b32 s30, 0, s30
    ds_read_b128 v[96:99], v236 offset:0
    ds_read_b64_tr_b16 v[100:101], v245 offset:0
    ds_read_b64_tr_b16 v[102:103], v245 offset:512
    ds_read_b64_tr_b16 v[104:105], v246 offset:0
    ds_read_b64_tr_b16 v[106:107], v246 offset:512
    ds_read_b128 v[108:111], v237 offset:0
    ds_read_b64_tr_b16 v[112:113], v245 offset:2048
    ds_read_b64_tr_b16 v[114:115], v245 offset:2560
    ds_read_b64_tr_b16 v[116:117], v246 offset:2048
    ds_read_b64_tr_b16 v[118:119], v246 offset:2560
    ds_read_b128 v[120:123], v238 offset:0
    ds_read_b64_tr_b16 v[124:125], v245 offset:4096
    ds_read_b64_tr_b16 v[126:127], v245 offset:4608
    ds_read_b64_tr_b16 v[128:129], v246 offset:4096
    ds_read_b64_tr_b16 v[130:131], v246 offset:4608
    ds_read_b128 v[132:135], v239 offset:0
    ds_read_b64_tr_b16 v[136:137], v245 offset:6144
    ds_read_b64_tr_b16 v[138:139], v245 offset:6656
    ds_read_b64_tr_b16 v[140:141], v246 offset:6144
    ds_read_b64_tr_b16 v[142:143], v246 offset:6656
    s_waitcnt lgkmcnt(15)
    v_mfma_f32_32x32x16_bf16 v[64:79], v[100:103], v[96:99], v[64:79]
    v_mfma_f32_32x32x16_bf16 v[80:95], v[104:107], v[96:99], v[80:95]
    s_waitcnt lgkmcnt(10)
    v_mfma_f32_32x32x16_bf16 v[64:79], v[112:115], v[108:111], v[64:79]
    v_mfma_f32_32x32x16_bf16 v[80:95], v[116:119], v[108:111], v[80:95]
    s_waitcnt lgkmcnt(5)
    v_mfma_f32_32x32x16_bf16 v[64:79], v[124:127], v[120:123], v[64:79]
    v_mfma_f32_32x32x16_bf16 v[80:95], v[128:131], v[120:123], v[80:95]
    s_waitcnt lgkmcnt(0)
    v_mfma_f32_32x32x16_bf16 v[64:79], v[136:139], v[132:135], v[64:79]
    v_mfma_f32_32x32x16_bf16 v[80:95], v[140:143], v[132:135], v[80:95]
    s_waitcnt vmcnt(28)
    s_barrier
    s_add_u32 m0, s28, 49152
    s_nop 0
    buffer_load_dwordx4 v2, s[4:7], s29 offen lds
    s_add_u32 m0, s28, 50176
    s_nop 0
    buffer_load_dwordx4 v3, s[4:7], s29 offen lds
    s_add_u32 m0, s28, 51200
    s_nop 0
    buffer_load_dwordx4 v4, s[4:7], s29 offen lds
    s_add_u32 m0, s28, 52224
    s_nop 0
    buffer_load_dwordx4 v5, s[4:7], s29 offen lds
    s_add_u32 m0, s31, 65536
    s_nop 0
    buffer_load_dwordx4 v10, s[8:11], s30 offen lds
    s_add_u32 m0, s31, 66560
    s_nop 0
    buffer_load_dwordx4 v11, s[8:11], s30 offen lds
    s_add_u32 m0, s41, 65536
    s_nop 0
    buffer_load_dwordx4 v247, s[8:11], s30 offen lds
    s_add_u32 s29, s29, 128
    s_add_u32 s30, s30, 81920
    s_cmp_eq_u32 s29, 1280
    s_cselect_b32 s29, 0, s29
    s_cselect_b32 s30, 0, s30
    ds_read_b128 v[144:147], v236 offset:24576
    ds_read_b64_tr_b16 v[148:149], v245 offset:24576
    ds_read_b64_tr_b16 v[150:151], v245 offset:25088
    ds_read_b64_tr_b16 v[152:153], v246 offset:24576
    ds_read_b64_tr_b16 v[154:155], v246 offset:25088
    ds_read_b128 v[156:159], v237 offset:24576
    ds_read_b64_tr_b16 v[160:161], v245 offset:26624
    ds_read_b64_tr_b16 v[162:163], v245 offset:27136
    ds_read_b64_tr_b16 v[164:165], v246 offset:26624
    ds_read_b64_tr_b16 v[166:167], v246 offset:27136
    ds_read_b128 v[168:171], v238 offset:24576
    ds_read_b64_tr_b16 v[172:173], v245 offset:28672
    ds_read_b64_tr_b16 v[174:175], v245 offset:29184
    ds_read_b64_tr_b16 v[176:177], v246 offset:28672
    ds_read_b64_tr_b16 v[178:179], v246 offset:29184
    ds_read_b128 v[180:183], v239 offset:24576
    ds_read_b64_tr_b16 v[184:185], v245 offset:30720
    ds_read_b64_tr_b16 v[186:187], v245 offset:31232
    ds_read_b64_tr_b16 v[188:189], v246 offset:30720
    ds_read_b64_tr_b16 v[190:191], v246 offset:31232
    s_waitcnt lgkmcnt(15)
    v_mfma_f32_32x32x16_bf16 v[64:79], v[148:151], v[144:147], v[64:79]
    v_mfma_f32_32x32x16_bf16 v[80:95], v[152:155], v[144:147], v[80:95]
    s_waitcnt lgkmcnt(10)
    v_mfma_f32_32x32x16_bf16 v[64:79], v[160:163], v[156:159], v[64:79]
    v_mfma_f32_32x32x16_bf16 v[80:95], v[164:167], v[156:159], v[80:95]
    s_waitcnt lgkmcnt(5)
    v_mfma_f32_32x32x16_bf16 v[64:79], v[172:175], v[168:171], v[64:79]
    v_mfma_f32_32x32x16_bf16 v[80:95], v[176:179], v[168:171], v[80:95]
    s_waitcnt lgkmcnt(0)
    v_mfma_f32_32x32x16_bf16 v[64:79], v[184:187], v[180:183], v[64:79]
    v_mfma_f32_32x32x16_bf16 v[80:95], v[188:191], v[180:183], v[80:95]
    s_waitcnt vmcnt(28)
    s_barrier
    s_add_u32 m0, s28, 73728
    s_nop 0
    buffer_load_dwordx4 v2, s[4:7], s29 offen lds
    s_add_u32 m0, s28, 74752
    s_nop 0
    buffer_load_dwordx4 v3, s[4:7], s29 offen lds
    s_add_u32 m0, s28, 75776
    s_nop 0
    buffer_load_dwordx4 v4, s[4:7], s29 offen lds
    s_add_u32 m0, s28, 76800
    s_nop 0
    buffer_load_dwordx4 v5, s[4:7], s29 offen lds
    s_add_u32 m0, s31, 90112
    s_nop 0
    buffer_load_dwordx4 v10, s[8:11], s30 offen lds
    s_add_u32 m0, s31, 91136
    s_nop 0
    buffer_load_dwordx4 v11, s[8:11], s30 offen lds
    s_add_u32 m0, s41, 90112
    s_nop 0
    buffer_load_dwordx4 v247, s[8:11], s30 offen lds
    s_add_u32 s29, s29, 128
    s_add_u32 s30, s30, 81920
    s_cmp_eq_u32 s29, 1280
    s_cselect_b32 s29, 0, s29
    s_cselect_b32 s30, 0, s30
    ds_read_b128 v[96:99], v240 offset:0
    ds_read_b64_tr_b16 v[100:101], v248 offset:0
    ds_read_b64_tr_b16 v[102:103], v248 offset:512
    ds_read_b64_tr_b16 v[104:105], v249 offset:0
    ds_read_b64_tr_b16 v[106:107], v249 offset:512
    ds_read_b128 v[108:111], v241 offset:0
    ds_read_b64_tr_b16 v[112:113], v248 offset:2048
    ds_read_b64_tr_b16 v[114:115], v248 offset:2560
    ds_read_b64_tr_b16 v[116:117], v249 offset:2048
    ds_read_b64_tr_b16 v[118:119], v249 offset:2560
    ds_read_b128 v[120:123], v242 offset:0
    ds_read_b64_tr_b16 v[124:125], v248 offset:4096
    ds_read_b64_tr_b16 v[126:127], v248 offset:4608
    ds_read_b64_tr_b16 v[128:129], v249 offset:4096
    ds_read_b64_tr_b16 v[130:131], v249 offset:4608
    ds_read_b128 v[132:135], v243 offset:0
    ds_read_b64_tr_b16 v[136:137], v248 offset:6144
    ds_read_b64_tr_b16 v[138:139], v248 offset:6656
    ds_read_b64_tr_b16 v[140:141], v249 offset:6144
    ds_read_b64_tr_b16 v[142:143], v249 offset:6656
    s_waitcnt lgkmcnt(15)
    v_mfma_f32_32x32x16_bf16 v[64:79], v[100:103], v[96:99], v[64:79]
    v_mfma_f32_32x32x16_bf16 v[80:95], v[104:107], v[96:99], v[80:95]
    s_waitcnt lgkmcnt(10)
    v_mfma_f32_32x32x16_bf16 v[64:79], v[112:115], v[108:111], v[64:79]
    v_mfma_f32_32x32x16_bf16 v[80:95], v[116:119], v[108:111], v[80:95]
    s_waitcnt lgkmcnt(5)
    v_mfma_f32_32x32x16_bf16 v[64:79], v[124:127], v[120:123], v[64:79]
    v_mfma_f32_32x32x16_bf16 v[80:95], v[128:131], v[120:123], v[80:95]
    s_waitcnt lgkmcnt(0)
    v_mfma_f32_32x32x16_bf16 v[64:79], v[136:139], v[132:135], v[64:79]
    v_mfma_f32_32x32x16_bf16 v[80:95], v[140:143], v[132:135], v[80:95]
    s_waitcnt vmcnt(28)
    s_barrier
    ds_read_b128 v[144:147], v240 offset:24576
    ds_read_b64_tr_b16 v[148:149], v248 offset:24576
    ds_read_b64_tr_b16 v[150:151], v248 offset:25088
    ds_read_b64_tr_b16 v[152:153], v249 offset:24576
    ds_read_b64_tr_b16 v[154:155], v249 offset:25088
    ds_read_b128 v[156:159], v241 offset:24576
    ds_read_b64_tr_b16 v[160:161], v248 offset:26624
    ds_read_b64_tr_b16 v[162:163], v248 offset:27136
    ds_read_b64_tr_b16 v[164:165], v249 offset:26624
    ds_read_b64_tr_b16 v[166:167], v249 offset:27136
    ds_read_b128 v[168:171], v242 offset:24576
    ds_read_b64_tr_b16 v[172:173], v248 offset:28672
    ds_read_b64_tr_b16 v[174:175], v248 offset:29184
    ds_read_b64_tr_b16 v[176:177], v249 offset:28672
    ds_read_b64_tr_b16 v[178:179], v249 offset:29184
    ds_read_b128 v[180:183], v243 offset:24576
    ds_read_b64_tr_b16 v[184:185], v248 offset:30720
    ds_read_b64_tr_b16 v[186:187], v248 offset:31232
    ds_read_b64_tr_b16 v[188:189], v249 offset:30720
    ds_read_b64_tr_b16 v[190:191], v249 offset:31232
    s_waitcnt lgkmcnt(15)
    v_mfma_f32_32x32x16_bf16 v[64:79], v[148:151], v[144:147], v[64:79]
    v_mfma_f32_32x32x16_bf16 v[80:95], v[152:155], v[144:147], v[80:95]
    s_waitcnt lgkmcnt(10)
    v_mfma_f32_32x32x16_bf16 v[64:79], v[160:163], v[156:159], v[64:79]
    v_mfma_f32_32x32x16_bf16 v[80:95], v[164:167], v[156:159], v[80:95]
    s_waitcnt lgkmcnt(5)
    v_mfma_f32_32x32x16_bf16 v[64:79], v[172:175], v[168:171], v[64:79]
    v_mfma_f32_32x32x16_bf16 v[80:95], v[176:179], v[168:171], v[80:95]
    s_waitcnt lgkmcnt(0)
    v_mfma_f32_32x32x16_bf16 v[64:79], v[184:187], v[180:183], v[64:79]
    v_mfma_f32_32x32x16_bf16 v[80:95], v[188:191], v[180:183], v[80:95]
    s_waitcnt vmcnt(21)
    s_barrier
    buffer_load_dword v13, v12, s[36:39], 0 offen
    s_add_u32 m0, s33, 0
    s_mov_b32 s26, 0
    buffer_load_dwordx4 v250, s[12:15], s26 offen lds
    s_add_u32 m0, s33, 1024
    s_mov_b32 s26, 10240
    buffer_load_dwordx4 v250, s[12:15], s26 offen lds
    s_add_u32 m0, s33, 2048
    s_mov_b32 s26, 20480
    buffer_load_dwordx4 v250, s[12:15], s26 offen lds
    s_add_u32 m0, s33, 3072
    s_mov_b32 s26, 30720
    buffer_load_dwordx4 v250, s[12:15], s26 offen lds
    s_add_u32 m0, s33, 4096
    s_mov_b32 s26, 2621440
    buffer_load_dwordx4 v250, s[12:15], s26 offen lds
    s_add_u32 m0, s33, 5120
    s_mov_b32 s26, 2631680
    buffer_load_dwordx4 v250, s[12:15], s26 offen lds
    s_add_u32 m0, s33, 6144
    s_mov_b32 s26, 2641920
    buffer_load_dwordx4 v250, s[12:15], s26 offen lds
    s_add_u32 m0, s33, 7168
    s_mov_b32 s26, 2652160
    buffer_load_dwordx4 v250, s[12:15], s26 offen lds
    ds_read_b128 v[96:99], v232 offset:0
    ds_read_b64_tr_b16 v[100:101], v7 offset:0
    ds_read_b64_tr_b16 v[102:103], v7 offset:512
    ds_read_b64_tr_b16 v[104:105], v8 offset:0
    ds_read_b64_tr_b16 v[106:107], v8 offset:512
    ds_read_b128 v[108:111], v233 offset:0
    ds_read_b64_tr_b16 v[112:113], v7 offset:2048
    ds_read_b64_tr_b16 v[114:115], v7 offset:2560
    ds_read_b64_tr_b16 v[116:117], v8 offset:2048
    ds_read_b64_tr_b16 v[118:119], v8 offset:2560
    ds_read_b128 v[120:123], v234 offset:0
    ds_read_b64_tr_b16 v[124:125], v7 offset:4096
    ds_read_b64_tr_b16 v[126:127], v7 offset:4608
    ds_read_b64_tr_b16 v[128:129], v8 offset:4096
    ds_read_b64_tr_b16 v[130:131], v8 offset:4608
    ds_read_b128 v[132:135], v235 offset:0
    ds_read_b64_tr_b16 v[136:137], v7 offset:6144
    ds_read_b64_tr_b16 v[138:139], v7 offset:6656
    ds_read_b64_tr_b16 v[140:141], v8 offset:6144
    ds_read_b64_tr_b16 v[142:143], v8 offset:6656
    s_waitcnt lgkmcnt(15)
    v_mfma_f32_32x32x16_bf16 v[64:79], v[100:103], v[96:99], v[64:79]
    v_mfma_f32_32x32x16_bf16 v[80:95], v[104:107], v[96:99], v[80:95]
    s_waitcnt lgkmcnt(10)
    v_mfma_f32_32x32x16_bf16 v[64:79], v[112:115], v[108:111], v[64:79]
    v_mfma_f32_32x32x16_bf16 v[80:95], v[116:119], v[108:111], v[80:95]
    s_waitcnt lgkmcnt(5)
    v_mfma_f32_32x32x16_bf16 v[64:79], v[124:127], v[120:123], v[64:79]
    v_mfma_f32_32x32x16_bf16 v[80:95], v[128:131], v[120:123], v[80:95]
    s_waitcnt lgkmcnt(0)
    v_mfma_f32_32x32x16_bf16 v[64:79], v[136:139], v[132:135], v[64:79]
    v_mfma_f32_32x32x16_bf16 v[80:95], v[140:143], v[132:135], v[80:95]
    s_waitcnt vmcnt(23)
    s_barrier
    ds_read_b128 v[144:147], v232 offset:24576
    ds_read_b64_tr_b16 v[148:149], v7 offset:24576
    ds_read_b64_tr_b16 v[150:151], v7 offset:25088
    ds_read_b64_tr_b16 v[152:153], v8 offset:24576
    ds_read_b64_tr_b16 v[154:155], v8 offset:25088
    ds_read_b128 v[156:159], v233 offset:24576
    ds_read_b64_tr_b16 v[160:161], v7 offset:26624
    ds_read_b64_tr_b16 v[162:163], v7 offset:27136
    ds_read_b64_tr_b16 v[164:165], v8 offset:26624
    ds_read_b64_tr_b16 v[166:167], v8 offset:27136
    ds_read_b128 v[168:171], v234 offset:24576
    ds_read_b64_tr_b16 v[172:173], v7 offset:28672
    ds_read_b64_tr_b16 v[174:175], v7 offset:29184
    ds_read_b64_tr_b16 v[176:177], v8 offset:28672
    ds_read_b64_tr_b16 v[178:179], v8 offset:29184
    ds_read_b128 v[180:183], v235 offset:24576
    ds_read_b64_tr_b16 v[184:185], v7 offset:30720
    ds_read_b64_tr_b16 v[186:187], v7 offset:31232
    ds_read_b64_tr_b16 v[188:189], v8 offset:30720
    ds_read_b64_tr_b16 v[190:191], v8 offset:31232
    s_waitcnt lgkmcnt(15)
    v_mfma_f32_32x32x16_bf16 v[64:79], v[148:151], v[144:147], v[64:79]
    v_mfma_f32_32x32x16_bf16 v[80:95], v[152:155], v[144:147], v[80:95]
    s_waitcnt lgkmcnt(10)
    v_mfma_f32_32x32x16_bf16 v[64:79], v[160:163], v[156:159], v[64:79]
    v_mfma_f32_32x32x16_bf16 v[80:95], v[164:167], v[156:159], v[80:95]
    s_waitcnt lgkmcnt(5)
    v_mfma_f32_32x32x16_bf16 v[64:79], v[172:175], v[168:171], v[64:79]
    v_mfma_f32_32x32x16_bf16 v[80:95], v[176:179], v[168:171], v[80:95]
    s_waitcnt lgkmcnt(0)
    v_mfma_f32_32x32x16_bf16 v[64:79], v[184:187], v[180:183], v[64:79]
    v_mfma_f32_32x32x16_bf16 v[80:95], v[188:191], v[180:183], v[80:95]
    s_waitcnt vmcnt(16)
    s_barrier
    ds_read_b128 v[96:99], v236 offset:0
    ds_read_b64_tr_b16 v[100:101], v245 offset:0
    ds_read_b64_tr_b16 v[102:103], v245 offset:512
    ds_read_b64_tr_b16 v[104:105], v246 offset:0
    ds_read_b64_tr_b16 v[106:107], v246 offset:512
    ds_read_b128 v[108:111], v237 offset:0
    ds_read_b64_tr_b16 v[112:113], v245 offset:2048
    ds_read_b64_tr_b16 v[114:115], v245 offset:2560
    ds_read_b64_tr_b16 v[116:117], v246 offset:2048
    ds_read_b64_tr_b16 v[118:119], v246 offset:2560
    ds_read_b128 v[120:123], v238 offset:0
    ds_read_b64_tr_b16 v[124:125], v245 offset:4096
    ds_read_b64_tr_b16 v[126:127], v245 offset:4608
    ds_read_b64_tr_b16 v[128:129], v246 offset:4096
    ds_read_b64_tr_b16 v[130:131], v246 offset:4608
    ds_read_b128 v[132:135], v239 offset:0
    ds_read_b64_tr_b16 v[136:137], v245 offset:6144
    ds_read_b64_tr_b16 v[138:139], v245 offset:6656
    ds_read_b64_tr_b16 v[140:141], v246 offset:6144
    ds_read_b64_tr_b16 v[142:143], v246 offset:6656
    s_waitcnt lgkmcnt(15)
    v_mfma_f32_32x32x16_bf16 v[64:79], v[100:103], v[96:99], v[64:79]
    v_mfma_f32_32x32x16_bf16 v[80:95], v[104:107], v[96:99], v[80:95]
    s_waitcnt lgkmcnt(10)
    v_mfma_f32_32x32x16_bf16 v[64:79], v[112:115], v[108:111], v[64:79]
    v_mfma_f32_32x32x16_bf16 v[80:95], v[116:119], v[108:111], v[80:95]
    s_waitcnt lgkmcnt(5)
    v_mfma_f32_32x32x16_bf16 v[64:79], v[124:127], v[120:123], v[64:79]
    v_mfma_f32_32x32x16_bf16 v[80:95], v[128:131], v[120:123], v[80:95]
    s_waitcnt lgkmcnt(0)
    v_mfma_f32_32x32x16_bf16 v[64:79], v[136:139], v[132:135], v[64:79]
    v_mfma_f32_32x32x16_bf16 v[80:95], v[140:143], v[132:135], v[80:95]
    s_waitcnt vmcnt(9)
    s_barrier
    ds_read_b128 v[144:147], v236 offset:24576
    ds_read_b64_tr_b16 v[148:149], v245 offset:24576
    ds_read_b64_tr_b16 v[150:151], v245 offset:25088
    ds_read_b64_tr_b16 v[152:153], v246 offset:24576
    ds_read_b64_tr_b16 v[154:155], v246 offset:25088
    ds_read_b128 v[156:159], v237 offset:24576
    ds_read_b64_tr_b16 v[160:161], v245 offset:26624
    ds_read_b64_tr_b16 v[162:163], v245 offset:27136
    ds_read_b64_tr_b16 v[164:165], v246 offset:26624
    ds_read_b64_tr_b16 v[166:167], v246 offset:27136
    ds_read_b128 v[168:171], v238 offset:24576
    ds_read_b64_tr_b16 v[172:173], v245 offset:28672
    ds_read_b64_tr_b16 v[174:175], v245 offset:29184
    ds_read_b64_tr_b16 v[176:177], v246 offset:28672
    ds_read_b64_tr_b16 v[178:179], v246 offset:29184
    ds_read_b128 v[180:183], v239 offset:24576
    ds_read_b64_tr_b16 v[184:185], v245 offset:30720
    ds_read_b64_tr_b16 v[186:187], v245 offset:31232
    ds_read_b64_tr_b16 v[188:189], v246 offset:30720
    ds_read_b64_tr_b16 v[190:191], v246 offset:31232
    s_waitcnt lgkmcnt(15)
    v_mfma_f32_32x32x16_bf16 v[64:79], v[148:151], v[144:147], v[64:79]
    v_mfma_f32_32x32x16_bf16 v[80:95], v[152:155], v[144:147], v[80:95]
    s_waitcnt lgkmcnt(10)
    v_mfma_f32_32x32x16_bf16 v[64:79], v[160:163], v[156:159], v[64:79]
    v_mfma_f32_32x32x16_bf16 v[80:95], v[164:167], v[156:159], v[80:95]
    s_waitcnt lgkmcnt(5)
    v_mfma_f32_32x32x16_bf16 v[64:79], v[172:175], v[168:171], v[64:79]
    v_mfma_f32_32x32x16_bf16 v[80:95], v[176:179], v[168:171], v[80:95]
    s_waitcnt lgkmcnt(0)
    v_mfma_f32_32x32x16_bf16 v[64:79], v[184:187], v[180:183], v[64:79]
    v_mfma_f32_32x32x16_bf16 v[80:95], v[188:191], v[180:183], v[80:95]
    s_waitcnt vmcnt(0)
    s_lshl_b32 s26, s20, 5
    s_add_u32 s26, s26, s21
    s_cmp_ge_u32 s26, 2048
    s_cbranch_scc1 Lo_end
    v_xor_b32 v2, 0, v251
    v_xor_b32 v3, 32, v251
    v_xor_b32 v4, 64, v251
    v_xor_b32 v5, 96, v251
    ds_read_b128 v[192:195], v2 offset:0
    ds_read_b128 v[196:199], v3 offset:0
    ds_read_b128 v[200:203], v4 offset:0
    ds_read_b128 v[204:207], v5 offset:0
    ds_read_b128 v[208:211], v2 offset:4096
    ds_read_b128 v[212:215], v3 offset:4096
    ds_read_b128 v[216:219], v4 offset:4096
    ds_read_b128 v[220:223], v5 offset:4096
    v_sub_f32 v14, 1.0, v13
    s_waitcnt lgkmcnt(0)
    v_lshlrev_b32 v16, 16, v192
    v_and_b32 v17, 0xffff0000, v192
    v_lshlrev_b32 v1, 16, v208
    v_and_b32 v208, 0xffff0000, v208
    v_add_f32 v16, v16, v1
    v_add_f32 v17, v17, v208
    v_lshlrev_b32 v18, 16, v193
    v_and_b32 v19, 0xffff0000, v193
    v_lshlrev_b32 v1, 16, v209
    v_and_b32 v209, 0xffff0000, v209
    v_add_f32 v18, v18, v1
    v_add_f32 v19, v19, v209
    v_lshlrev_b32 v20, 16, v194
    v_and_b32 v21, 0xffff0000, v194
    v_lshlrev_b32 v1, 16, v210
    v_and_b32 v210, 0xffff0000, v210
    v_add_f32 v20, v20, v1
    v_add_f32 v21, v21, v210
    v_lshlrev_b32 v22, 16, v195
    v_and_b32 v23, 0xffff0000, v195
    v_lshlrev_b32 v1, 16, v211
    v_and_b32 v211, 0xffff0000, v211
    v_add_f32 v22, v22, v1
    v_add_f32 v23, v23, v211
    v_lshlrev_b32 v24, 16, v196
    v_and_b32 v25, 0xffff0000, v196
    v_lshlrev_b32 v1, 16, v212
    v_and_b32 v212, 0xffff0000, v212
    v_add_f32 v24, v24, v1
    v_add_f32 v25, v25, v212
    v_lshlrev_b32 v26, 16, v197
    v_and_b32 v27, 0xffff0000, v197
    v_lshlrev_b32 v1, 16, v213
    v_and_b32 v213, 0xffff0000, v213
    v_add_f32 v26, v26, v1
    v_add_f32 v27, v27, v213
    v_lshlrev_b32 v28, 16, v198
    v_and_b32 v29, 0xffff0000, v198
    v_lshlrev_b32 v1, 16, v214
    v_and_b32 v214, 0xffff0000, v214
    v_add_f32 v28, v28, v1
    v_add_f32 v29, v29, v214
    v_lshlrev_b32 v30, 16, v199
    v_and_b32 v31, 0xffff0000, v199
    v_lshlrev_b32 v1, 16, v215
    v_and_b32 v215, 0xffff0000, v215
    v_add_f32 v30, v30, v1
    v_add_f32 v31, v31, v215
    v_lshlrev_b32 v32, 16, v200
    v_and_b32 v33, 0xffff0000, v200
    v_lshlrev_b32 v1, 16, v216
    v_and_b32 v216, 0xffff0000, v216
    v_add_f32 v32, v32, v1
    v_add_f32 v33, v33, v216
    v_lshlrev_b32 v34, 16, v201
    v_and_b32 v35, 0xffff0000, v201
    v_lshlrev_b32 v1, 16, v217
    v_and_b32 v217, 0xffff0000, v217
    v_add_f32 v34, v34, v1
    v_add_f32 v35, v35, v217
    v_lshlrev_b32 v36, 16, v202
    v_and_b32 v37, 0xffff0000, v202
    v_lshlrev_b32 v1, 16, v218
    v_and_b32 v218, 0xffff0000, v218
    v_add_f32 v36, v36, v1
    v_add_f32 v37, v37, v218
    v_lshlrev_b32 v38, 16, v203
    v_and_b32 v39, 0xffff0000, v203
    v_lshlrev_b32 v1, 16, v219
    v_and_b32 v219, 0xffff0000, v219
    v_add_f32 v38, v38, v1
    v_add_f32 v39, v39, v219
    v_lshlrev_b32 v40, 16, v204
    v_and_b32 v41, 0xffff0000, v204
    v_lshlrev_b32 v1, 16, v220
    v_and_b32 v220, 0xffff0000, v220
    v_add_f32 v40, v40, v1
    v_add_f32 v41, v41, v220
    v_lshlrev_b32 v42, 16, v205
    v_and_b32 v43, 0xffff0000, v205
    v_lshlrev_b32 v1, 16, v221
    v_and_b32 v221, 0xffff0000, v221
    v_add_f32 v42, v42, v1
    v_add_f32 v43, v43, v221
    v_lshlrev_b32 v44, 16, v206
    v_and_b32 v45, 0xffff0000, v206
    v_lshlrev_b32 v1, 16, v222
    v_and_b32 v222, 0xffff0000, v222
    v_add_f32 v44, v44, v1
    v_add_f32 v45, v45, v222
    v_lshlrev_b32 v46, 16, v207
    v_and_b32 v47, 0xffff0000, v207
    v_lshlrev_b32 v1, 16, v223
    v_and_b32 v223, 0xffff0000, v223
    v_add_f32 v46, v46, v1
    v_add_f32 v47, v47, v223
    v_mul_f32 v16, v16, v14
    v_fma_f32 v64, v64, v13, v16
    v_mul_f32 v17, v17, v14
    v_fma_f32 v65, v65, v13, v17
    v_mul_f32 v18, v18, v14
    v_fma_f32 v66, v66, v13, v18
    v_mul_f32 v19, v19, v14
    v_fma_f32 v67, v67, v13, v19
    v_mul_f32 v20, v20, v14
    v_fma_f32 v68, v68, v13, v20
    v_mul_f32 v21, v21, v14
    v_fma_f32 v69, v69, v13, v21
    v_mul_f32 v22, v22, v14
    v_fma_f32 v70, v70, v13, v22
    v_mul_f32 v23, v23, v14
    v_fma_f32 v71, v71, v13, v23
    v_mul_f32 v24, v24, v14
    v_fma_f32 v72, v72, v13, v24
    v_mul_f32 v25, v25, v14
    v_fma_f32 v73, v73, v13, v25
    v_mul_f32 v26, v26, v14
    v_fma_f32 v74, v74, v13, v26
    v_mul_f32 v27, v27, v14
    v_fma_f32 v75, v75, v13, v27
    v_mul_f32 v28, v28, v14
    v_fma_f32 v76, v76, v13, v28
    v_mul_f32 v29, v29, v14
    v_fma_f32 v77, v77, v13, v29
    v_mul_f32 v30, v30, v14
    v_fma_f32 v78, v78, v13, v30
    v_mul_f32 v31, v31, v14
    v_fma_f32 v79, v79, v13, v31
    v_mul_f32 v32, v32, v14
    v_fma_f32 v80, v80, v13, v32
    v_mul_f32 v33, v33, v14
    v_fma_f32 v81, v81, v13, v33
    v_mul_f32 v34, v34, v14
    v_fma_f32 v82, v82, v13, v34
    v_mul_f32 v35, v35, v14
    v_fma_f32 v83, v83, v13, v35
    v_mul_f32 v36, v36, v14
    v_fma_f32 v84, v84, v13, v36
    v_mul_f32 v37, v37, v14
    v_fma_f32 v85, v85, v13, v37
    v_mul_f32 v38, v38, v14
    v_fma_f32 v86, v86, v13, v38
    v_mul_f32 v39, v39, v14
    v_fma_f32 v87, v87, v13, v39
    v_mul_f32 v40, v40, v14
    v_fma_f32 v88, v88, v13, v40
    v_mul_f32 v41, v41, v14
    v_fma_f32 v89, v89, v13, v41
    v_mul_f32 v42, v42, v14
    v_fma_f32 v90, v90, v13, v42
    v_mul_f32 v43, v43, v14
    v_fma_f32 v91, v91, v13, v43
    v_mul_f32 v44, v44, v14
    v_fma_f32 v92, v92, v13, v44
    v_mul_f32 v45, v45, v14
    v_fma_f32 v93, v93, v13, v45
    v_mul_f32 v46, v46, v14
    v_fma_f32 v94, v94, v13, v46
    v_mul_f32 v47, v47, v14
    v_fma_f32 v95, v95, v13, v47
    v_cvt_pk_bf16_f32 v192, v64, v65
    v_cvt_pk_bf16_f32 v193, v66, v67
    v_cvt_pk_bf16_f32 v194, v68, v69
    v_cvt_pk_bf16_f32 v195, v70, v71
    v_cvt_pk_bf16_f32 v196, v72, v73
    v_cvt_pk_bf16_f32 v197, v74, v75
    v_cvt_pk_bf16_f32 v198, v76, v77
    v_cvt_pk_bf16_f32 v199, v78, v79
    v_cvt_pk_bf16_f32 v200, v80, v81
    v_cvt_pk_bf16_f32 v201, v82, v83
    v_cvt_pk_bf16_f32 v202, v84, v85
    v_cvt_pk_bf16_f32 v203, v86, v87
    v_cvt_pk_bf16_f32 v204, v88, v89
    v_cvt_pk_bf16_f32 v205, v90, v91
    v_cvt_pk_bf16_f32 v206, v92, v93
    v_cvt_pk_bf16_f32 v207, v94, v95
    ds_write_b128 v2, v[192:195]
    ds_write_b128 v3, v[196:199]
    ds_write_b128 v4, v[200:203]
    ds_write_b128 v5, v[204:207]
    v_lshlrev_b32 v1, 4, v0
    v_add_u32 v1, s33, v1
    s_waitcnt lgkmcnt(0)
    ds_read_b128 v[208:211], v1 offset:0
    ds_read_b128 v[212:215], v1 offset:1024
    ds_read_b128 v[216:219], v1 offset:2048
    ds_read_b128 v[220:223], v1 offset:3072
    s_waitcnt lgkmcnt(3)
    s_mov_b32 s26, 0
    buffer_store_dwordx4 v[208:211], v250, s[16:19], s26 offen sc1
    s_waitcnt lgkmcnt(2)
    s_mov_b32 s26, 10240
    buffer_store_dwordx4 v[212:215], v250, s[16:19], s26 offen sc1
    s_waitcnt lgkmcnt(1)
    s_mov_b32 s26, 20480
    buffer_store_dwordx4 v[216:219], v250, s[16:19], s26 offen sc1
    s_waitcnt lgkmcnt(0)
    s_mov_b32 s26, 30720
    buffer_store_dwordx4 v[220:223], v250, s[16:19], s26 offen sc1
Lo_end:
    s_endpgm
.section .rodata,"a"
.p2align 6
.amdhsa_kernel proj_kernel
  .amdhsa_next_free_vgpr 128
  .amdhsa_next_free_sgpr 102
  .amdhsa_accum_offset 128
  .amdhsa_group_segment_fixed_size 0
  .amdhsa_kernarg_size 104
  .amdhsa_user_sgpr_count 2
  .amdhsa_user_sgpr_kernarg_segment_ptr 1
  .amdhsa_system_sgpr_workgroup_id_x 1
.end_amdhsa_kernel
.p2align 6
.amdhsa_kernel att_kernel
  .amdhsa_next_free_vgpr 128
  .amdhsa_next_free_sgpr 102
  .amdhsa_accum_offset 128
  .amdhsa_group_segment_fixed_size 0
  .amdhsa_kernarg_size 104
  .amdhsa_user_sgpr_count 2
  .amdhsa_user_sgpr_kernarg_segment_ptr 1
  .amdhsa_system_sgpr_workgroup_id_x 1
.end_amdhsa_kernel
.p2align 6
.amdhsa_kernel out_kernel
  .amdhsa_next_free_vgpr 252
  .amdhsa_next_free_sgpr 102
  .amdhsa_accum_offset 252
  .amdhsa_group_segment_fixed_size 0
  .amdhsa_kernarg_size 104
  .amdhsa_user_sgpr_count 2
  .amdhsa_user_sgpr_kernarg_segment_ptr 1
  .amdhsa_system_sgpr_workgroup_id_x 1
.end_amdhsa_kernel
```
